```python
import torch

def _softmax(x, axis=-1):
    return torch.softmax(x, dim=axis)
def _gelu(x):
    return torch.nn.functional.gelu(x, approximate="tanh")
def _silu(x):
    return torch.nn.functional.silu(x)
def _sigmoid(x):
    return torch.sigmoid(x)
def _layernorm(x, axis=-1, eps=1e-5):
    m = x.mean(dim=axis, keepdim=True)
    v = x.var(dim=axis, keepdim=True, unbiased=False)
    return (x - m) / torch.sqrt(v + eps)
def _scatter_add(tgt, idx, src, axis=0):
    return tgt.clone().index_add_(axis, idx, src)
def _segment_sum(src, seg, n):
    out = torch.zeros((n,) + src.shape[1:], dtype=src.dtype)
    return out.index_add_(0, seg, src)
def _pad(x, pw):
    flat = tuple(v for pair in reversed(pw) for v in pair)
    return torch.nn.functional.pad(x, flat)

kernel_name = 'sequential_preLN__linear_kernel_hedgehog__dense_activation_squared_relu__prompt'

def setup_inputs():

    _w = (lambda a: (lambda t: t.to(torch.bfloat16) if t.is_floating_point() else t)(torch.as_tensor(a)))
    def _A_setup():
        B, S, D, H = 1, 2048, 448, 16
        Dh = D // H
        return {
            "x": _w((lambda *s: torch.randn(*s, dtype=torch.bfloat16) * 0.05)(B, S, D)),
            "wqkv": _w((lambda *s: torch.randn(*s, dtype=torch.bfloat16) * 0.2)(D, 3 * D)),
            "w_phi": _w((lambda *s: torch.randn(*s, dtype=torch.bfloat16) * 0.2)(H, Dh, Dh) * (Dh ** -0.5)),
            "wo": _w((lambda *s: torch.randn(*s, dtype=torch.bfloat16) * 0.05)(D, D)),
        }
    _A_in = _A_setup()

    def _B_setup():
        B, S, D, F = 1, 2048, 448, 1792
        return {
            "x": _w((lambda *s: torch.randn(*s, dtype=torch.bfloat16) * 0.05)(B, S, D)),
            "w1": _w((lambda *s: torch.randn(*s, dtype=torch.bfloat16) * 0.05)(D, F)),
            "b1": _w((lambda *s: torch.randn(*s, dtype=torch.bfloat16) * 0.2)(F)),
            "w2": _w((lambda *s: torch.randn(*s, dtype=torch.bfloat16) * 0.05)(F, D)),
            "b2": _w((lambda *s: torch.randn(*s, dtype=torch.bfloat16) * 1.6)(D)),
        }
    _B_in = _B_setup()

    return {
        "A_x": _A_in["x"],
        "A_wqkv": _A_in["wqkv"],
        "A_w_phi": _A_in["w_phi"],
        "A_wo": _A_in["wo"],
        "B_x": _B_in["x"],
        "B_w1": _B_in["w1"],
        "B_b1": _B_in["b1"],
        "B_w2": _B_in["w2"],
        "B_b2": _B_in["b2"],
    }

def reference(A_x, A_wqkv, A_w_phi, A_wo, B_x, B_w1, B_b1, B_w2, B_b2):
    def _A_ref(x, wqkv, w_phi, wo):
        B, S, D = x.shape
        H = 16; Dh = D // H
        qkv = (lambda x, *d: x.permute(*d))((x @ wqkv).reshape(B, S, 3, H, Dh), 2, 0, 3, 1, 4)
        q, k, v = qkv[0], qkv[1], qkv[2]
        pq = torch.einsum("bhsd,hdf->bhsf", q, w_phi)
        pk = torch.einsum("bhsd,hdf->bhsf", k, w_phi)
        phi_q = torch.concatenate([_softmax(pq, axis=-1), _softmax(-pq, axis=-1)], axis=-1)
        phi_k = torch.concatenate([_softmax(pk, axis=-1), _softmax(-pk, axis=-1)], axis=-1)
        kv = torch.einsum("bhsf,bhsd->bhfd", phi_k, v)
        z  = torch.einsum("bhsf->bhf", phi_k)
        num = torch.einsum("bhqf,bhfd->bhqd", phi_q, kv)
        den = torch.einsum("bhqf,bhf->bhq", phi_q, z)[..., None] + 1e-6
        o = num / den
        return (lambda x, *d: x.permute(*d))(o, 0, 2, 1, 3).reshape(B, S, D) @ wo

    def _B_ref(x, w1, b1, w2, b2):
        h = torch.einsum("bsd,df->bsf", x, w1) + b1
        zero = torch.zeros_like(h)
        r = torch.where(h > zero, h, zero)
        h = r * r
        out = torch.einsum("bsf,fd->bsd", h, w2) + b2
        return out

    x = A_x
    h = x + _A_ref(_layernorm(x, axis=-1), A_wqkv, A_w_phi, A_wo)
    h2 = h + _B_ref(_layernorm(h, axis=-1), B_w1, B_b1, B_w2, B_b2)
    return h2
```

```asm
; @launch grid=(256,1,1) block=(256,1,1) lds=163840
.amdgcn_target "amdgcn-amd-amdhsa--gfx950"
.text
.globl sequential_preLN__linear_kernel_hedgehog__dense_activation_squared_relu__prompt_kernel
.p2align 12
.type sequential_preLN__linear_kernel_hedgehog__dense_activation_squared_relu__prompt_kernel,@function
sequential_preLN__linear_kernel_hedgehog__dense_activation_squared_relu__prompt_kernel:
    s_cmp_ge_u32 s2, 256
    s_cbranch_scc1 L_end
    s_load_dwordx2 s[8:9], s[0:1], 0
    s_load_dwordx2 s[12:13], s[0:1], 8
    s_load_dwordx2 s[16:17], s[0:1], 16
    s_load_dwordx2 s[20:21], s[0:1], 24
    s_load_dwordx2 s[24:25], s[0:1], 40
    s_load_dwordx2 s[28:29], s[0:1], 48
    s_load_dwordx2 s[32:33], s[0:1], 56
    s_load_dwordx2 s[36:37], s[0:1], 64
    s_load_dwordx2 s[40:41], s[0:1], 72
    s_load_dwordx2 s[44:45], s[0:1], 80
    s_load_dwordx2 s[48:49], s[0:1], 88
    v_lshrrev_b32 v1, 6, v0
    v_and_b32 v0, 63, v0
    v_readfirstlane_b32 s3, v1
    s_and_b32 s7, s2, 7
    s_lshr_b32 s5, s2, 3
    s_lshr_b32 s4, s5, 4
    s_lshl_b32 s7, s7, 1
    s_add_u32 s4, s4, s7
    s_and_b32 s5, s5, 15
    v_lshrrev_b32 v30, 3, v0
    v_lshrrev_b32 v31, 4, v0
    v_and_b32 v5, 7, v0
    v_xor_b32 v5, v5, v31
    v_lshlrev_b32 v5, 4, v5
    s_movk_i32 s7, 896
    v_mad_u32_u24 v5, v30, s7, v5
    v_xor_b32 v6, 64, v5
    v_lshrrev_b32 v7, 2, v0
    v_xor_b32 v7, v7, v31
    v_and_b32 v7, 1, v7
    v_add_u32 v7, 1, v7
    v_mul_u32_u24 v7, s7, v7
    s_movk_i32 s7, 2688
    v_mad_u32_u24 v7, v30, s7, v7
    v_and_b32 v31, 3, v0
    v_lshl_add_u32 v7, v31, 4, v7
    s_lshl_b32 s56, s4, 2
    s_add_u32 s56, s56, s3
    s_mul_i32 s56, s56, 28672
    s_cmp_eq_u32 s5, 15
    s_cselect_b32 s73, 8, 0
    s_mul_i32 s57, s3, 43008
    s_mul_i32 s72, s5, 56
    s_sub_u32 s72, s72, s73
    s_add_u32 s57, s57, s72
    s_mul_i32 s58, s3, 16384
    s_add_u32 s58, s58, 58368
    s_mul_i32 s59, s3, 2080
    s_and_b32 s7, s4, 1
    s_mul_i32 s7, s7, 3
    s_mul_i32 s99, s5, 1
    s_add_u32 s99, s99, s7
    s_mul_i32 s7, s99, 37
    s_lshr_b32 s7, s7, 8
    s_mul_i32 s7, s7, 7
    s_sub_u32 s99, s99, s7
    s_sub_u32 s55, 7, s99
    s_sub_u32 s62, 7, s99
    s_lshl_b32 s7, s99, 7
    s_add_u32 s65, s56, s7
    s_mul_i32 s7, s99, 172032
    s_add_u32 s60, s57, s7
    s_mov_b64 exec, 0
    s_bitcmp1_b32 s3, 1
    s_cbranch_scc1 L_ihka_hi
    s_bitcmp1_b32 s3, 0
    s_cbranch_scc1 L_ihka_1
    s_branch L_ihka_0
L_ihka_hi:
    s_bitcmp1_b32 s3, 0
    s_cbranch_scc1 L_ihka_3
    s_branch L_ihka_2
L_ihka_ret:
    s_mov_b64 exec, -1
    s_waitcnt lgkmcnt(0)
    s_and_b32 s9, s9, 0xffff
    s_mov_b32 s10, 1835008
    s_mov_b32 s11, 0x00020000
    s_and_b32 s13, s13, 0xffff
    s_mov_b32 s14, 1204224
    s_mov_b32 s15, 0x00020000
    s_add_u32 m0, s59, 0
    s_nop 0
    buffer_load_dwordx4 v7, s[12:15], s60 offen lds
    s_add_u32 m0, s59, 0
    s_add_u32 s74, s60, 20464
    s_add_u32 s60, s60, 172032
    s_sub_u32 s62, s62, 1
    s_cmp_eq_u32 s62, 0
    s_cselect_b32 s60, s57, s60
    buffer_load_dwordx4 v7, s[12:15], s74 offen offset:1040 lds
    s_add_u32 m0, s58, 0
    s_nop 0
    buffer_load_dwordx4 v5, s[8:11], s65 offen lds
    v_mul_u32_u24 v30, 37, v0
    v_lshrrev_b32 v30, 8, v30
    v_mul_u32_u24 v31, 7, v30
    v_sub_u32 v31, v0, v31
    v_lshlrev_b32 v31, 7, v31
    s_mov_b32 s7, 172032
    v_mad_u32_u24 v64, v30, s7, v31
    s_movk_i32 s7, 2688
    v_mad_u32_u24 v65, v30, s7, v31
    v_lshlrev_b32 v20, 7, v0
    s_lshr_b32 s7, s2, 3
    s_lshl_b32 s98, s7, 2
    s_add_u32 s98, s98, s3
    s_bfe_u32 s7, s98, 0x20004
    s_mul_i32 s95, s7, 401408
    s_and_b32 s7, s98, 15
    s_mul_i32 s7, s7, 1792
    s_add_u32 s95, s95, s7
    s_mov_b32 s52, 1329540880
    s_mov_b32 s53, 4294440693
    s_lshl_b32 s7, s5, 2
    s_lshr_b64 s[52:53], s[52:53], s7
    s_and_b32 s7, s52, 15
    s_cmp_eq_u32 s7, 15
    s_cselect_b32 s90, 0x40000000, 0
    s_and_b32 s7, s7, 7
    s_lshl_b32 s93, s7, 2
    s_add_u32 s93, s93, s3
    s_and_b32 s7, s4, 1
    s_lshl_b32 s7, s7, 5
    s_add_u32 s93, s93, s7
    s_bfe_u32 s7, s93, 0x20003
    s_mul_i32 s91, s7, 401408
    s_and_b32 s7, s93, 7
    s_mul_i32 s7, s7, 3584
    s_add_u32 s91, s91, s7
    s_mov_b32 s52, 1733567248
    s_mov_b32 s53, 3741104777
    s_lshl_b32 s7, s5, 2
    s_lshr_b64 s[52:53], s[52:53], s7
    s_and_b32 s91, s52, 15
    v_add_u32 v66, s90, v20
    s_and_b32 s17, s17, 0xffff
    s_mov_b32 s18, 25088
    s_mov_b32 s19, 0x00020000
    s_and_b32 s21, s21, 0xffff
    s_mov_b32 s22, 401408
    s_mov_b32 s23, 0x00020000
    s_and_b32 s25, s25, 0xffff
    s_mov_b32 s26, 1605632
    s_mov_b32 s27, 0x00020000
    s_and_b32 s29, s29, 0xffff
    s_mov_b32 s30, 3584
    s_mov_b32 s31, 0x00020000
    s_and_b32 s33, s33, 0xffff
    s_mov_b32 s34, 1605632
    s_mov_b32 s35, 0x00020000
    s_and_b32 s37, s37, 0xffff
    s_mov_b32 s38, 896
    s_mov_b32 s39, 0x00020000
    s_and_b32 s41, s41, 0xffff
    s_mov_b32 s42, 1835008
    s_mov_b32 s43, 0x00020000
    s_and_b32 s45, s45, 0xffff
    s_mov_b32 s46, 256
    s_mov_b32 s47, 0x00020000
    s_add_u32 s48, s48, 234881024
    s_addc_u32 s49, s49, 0
    s_and_b32 s49, s49, 0xffff
    s_mov_b32 s50, 33554432
    s_mov_b32 s51, 0x00020000
    s_or_b32 s7, s2, s3
    s_cmp_lg_u32 s7, 0
    s_cbranch_scc1 L_nononce
    s_memrealtime s[52:53]
    s_waitcnt lgkmcnt(0)
    s_lshl_b32 s53, s53, 4
    s_or_b32 s53, s53, 0x40000000
    v_mov_b32 v250, s52
    v_mov_b32 v251, s53
    s_mov_b64 exec, 1
    buffer_store_dwordx2 v[250:251], off, s[44:47], 0 sc1
    s_mov_b64 exec, -1
    s_nop 1
L_nononce:
    v_lshlrev_b32 v1, 4, v0
    v_mov_b32 v252, -1
L_ihka_0:
    s_cbranch_execz L_ihka_ret
    v_mov_b32 v253, -1
    v_mov_b32 v254, -1
    v_mov_b32 v255, -1
    s_mul_i32 s63, s4, 720896
    s_add_u32 s63, s63, 2097152
    s_lshl_b32 s54, s5, 2
    s_add_u32 s54, s54, s3
    s_lshl_b32 s96, s54, 12
    s_add_u32 s96, s96, s63
    s_lshl_b32 s54, s54, 4
    s_add_u32 s54, s54, s4
    s_lshl_b32 s54, s54, 6
    s_add_u32 s54, s54, 13697024
    s_lshl_b32 s70, s5, 4
    s_add_u32 s70, s70, s4
    s_lshl_b32 s70, s70, 2
    s_add_u32 s70, s70, s3
    s_lshl_b32 s70, s70, 11
    s_getreg_b32 s68, hwreg(HW_REG_XCC_ID, 0, 4)
    v_lshrrev_b32 v100, 5, v0
    v_bfe_u32 v101, v0, 2, 2
    v_and_b32 v102, 3, v0
    v_bfe_u32 v103, v0, 4, 1
    v_and_b32 v104, 31, v0
    v_bfe_u32 v30, v0, 1, 3
    s_add_u32 m0, s58, 0
    s_add_u32 s74, s65, 6144
    buffer_load_dwordx4 v6, s[8:11], s74 offen offset:1024 lds
    v_xor_b32 v30, v30, v100
    v_lshlrev_b32 v31, 7, v104
    v_add_u32 v31, s58, v31
    v_xor_b32 v9, 0, v30
    v_lshl_add_u32 v9, v9, 4, v31
    v_xor_b32 v10, 2, v30
    v_lshl_add_u32 v10, v10, 4, v31
    v_xor_b32 v11, 4, v30
    v_lshl_add_u32 v11, v11, 4, v31
    s_add_u32 m0, s58, 0
    s_add_u32 s74, s65, 12288
    buffer_load_dwordx4 v5, s[8:11], s74 offen offset:2048 lds
    v_xor_b32 v12, 6, v30
    v_lshl_add_u32 v12, v12, 4, v31
    v_lshlrev_b32 v105, 5, v103
    v_lshl_add_u32 v105, v102, 3, v105
    v_add_u32 v106, s73, v105
    v_min_u32 v106, 56, v106
    v_mul_u32_u24 v30, 1040, v100
    v_lshl_add_u32 v30, v101, 7, v30
    v_add_u32 v30, v30, v106
    s_add_u32 m0, s58, 0
    s_add_u32 s74, s65, 18432
    s_add_u32 s65, s65, 128
    s_sub_u32 s55, s55, 1
    s_cmp_eq_u32 s55, 0
    s_cselect_b32 s65, s56, s65
    buffer_load_dwordx4 v6, s[8:11], s74 offen offset:3072 lds
    v_lshrrev_b32 v31, 1, v101
    v_lshl_add_u32 v13, v31, 6, v30
    v_xor_b32 v31, 1, v31
    v_lshl_add_u32 v15, v31, 6, v30
    v_add_u32 v14, 512, v13
    v_cmp_eq_u32 vcc, 56, v105
    v_mov_b32 v30, 1024
    s_nop 0
    v_cndmask_b32 v13, v13, v30, vcc
    v_cndmask_b32 v14, v14, v30, vcc
    s_add_u32 m0, s59, 8320
    s_nop 0
    buffer_load_dwordx4 v7, s[12:15], s60 offen lds
    v_min_u32 v30, 27, v0
    v_mul_u32_u24 v30, 2080, v30
    v_mov_b32 v108, 0x3f80
    v_mov_b32 v109, 0
    v_mov_b32 v110, 0
    v_mov_b32 v111, 0
    v_mov_b32 v28, 0
    v_mov_b32 v29, 0
    v_mov_b32 v88, 0
    s_add_u32 m0, s59, 8320
    s_add_u32 s74, s60, 20464
    s_add_u32 s60, s60, 172032
    s_sub_u32 s62, s62, 1
    s_cmp_eq_u32 s62, 0
    s_cselect_b32 s60, s57, s60
    buffer_load_dwordx4 v7, s[12:15], s74 offen offset:1040 lds
    v_mov_b32 v89, 0
    v_mov_b32 v90, 0
    v_mov_b32 v91, 0
    ds_write_b64 v30, v[108:109] offset:1024
    v_mov_b32 v31, 163712
    ds_write_b64 v31, v[110:111]
    v_lshl_add_u32 v31, v100, 3, v101
    v_lshl_add_u32 v31, v31, 6, v106
    v_add_u32 v19, 123904, v31
    s_mul_i32 s7, s3, 7168
    v_add_u32 v95, s7, v19
    v_lshrrev_b32 v8, 2, v0
    s_add_u32 m0, s58, 4096
    s_nop 0
    buffer_load_dwordx4 v5, s[8:11], s65 offen lds
    s_movk_i32 s7, 2688
    v_mul_u32_u24 v8, s7, v8
    v_lshl_add_u32 v8, v102, 4, v8
    v_subrev_u32 v30, 8, v105
    v_cndmask_b32 v30, v105, v30, vcc
    v_lshl_add_u32 v31, v100, 2, v101
    v_mul_u32_u24 v26, 56, v31
    v_add_u32 v26, v30, v26
    v_add_u32 v26, 158720, v26
    v_add_u32 v27, 1344, v26
    s_add_u32 m0, s58, 4096
    s_add_u32 s74, s65, 6144
    buffer_load_dwordx4 v6, s[8:11], s74 offen offset:1024 lds
    v_cmp_eq_u32 vcc, 1, v100
    v_mov_b32 v30, 163712
    s_nop 0
    v_cndmask_b32 v27, v27, v30, vcc
    v_mov_b32 v30, 0xf149f2ca
    v_cndmask_b32 v24, 0, v30, vcc
    s_mul_i32 s67, s3, 14336
    v_lshl_add_u32 v31, v31, 7, v105
    v_add_u32 v31, s67, v31
    s_lshr_b32 s7, s3, 1
    v_lshrrev_b32 v30, 1, v101
    v_xor_b32 v30, s7, v30
    s_add_u32 m0, s58, 4096
    s_add_u32 s74, s65, 12288
    buffer_load_dwordx4 v5, s[8:11], s74 offen offset:2048 lds
    v_lshl_add_u32 v3, v30, 6, v31
    v_xor_b32 v4, 64, v3
    v_lshrrev_b32 v30, 2, v0
    v_and_b32 v30, 4, v30
    v_and_b32 v31, 7, v0
    v_xor_b32 v30, v30, v31
    v_lshrrev_b32 v31, 3, v0
    v_mul_u32_u24 v31, 896, v31
    v_lshl_add_u32 v2, v30, 4, v31
    s_add_u32 m0, s58, 4096
    s_add_u32 s74, s65, 18432
    s_add_u32 s65, s65, 128
    s_sub_u32 s55, s55, 1
    s_cmp_eq_u32 s55, 0
    s_cselect_b32 s65, s56, s65
    buffer_load_dwordx4 v6, s[8:11], s74 offen offset:3072 lds
    s_sub_u32 s7, s5, 7
    s_cmp_ge_u32 s5, 7
    s_cselect_b32 s71, s7, s5
    s_cselect_b32 s6, 1, 0
    s_sub_u32 s7, s71, 7
    s_cmp_ge_u32 s71, 7
    s_cselect_b32 s71, s7, s71
    s_mul_i32 s66, s3, 401408
    s_lshl_b32 s7, s71, 7
    s_add_u32 s66, s66, s7
    s_mul_i32 s75, s3, 100352
    s_add_u32 s75, s75, s7
    v_mul_u32_u24 v21, 200, v104
    v_lshl_add_u32 v21, v100, 3, v21
    v_add_u32 v21, s58, v21
    v_lshrrev_b32 v30, 2, v0
    v_mul_u32_u24 v30, 200, v30
    v_lshl_add_u32 v30, v102, 3, v30
    v_add_u32 v23, 58496, v30
    s_lshl_b32 s7, s3, 5
    s_add_u32 s7, s7, 58368
    v_add_u32 v22, s7, v30
    s_mov_b32 s64, 0x3f803f80
    v_and_b32 v31, 15, v0
    s_lshl_b32 s7, s4, 4
    v_add_u32 v249, s7, v31
    s_lshl_b32 s7, s5, 4
    s_add_u32 s7, s7, 512
    v_add_u32 v31, s7, v31
    v_cmp_eq_u32 vcc, 0, v103
    s_nop 1
    v_cndmask_b32 v249, v31, v249, vcc
    v_lshlrev_b32 v249, 3, v249
    v_add_u32 v249, 13631488, v249
    s_waitcnt lgkmcnt(0)
L_ihka_1:
    s_cbranch_execz L_ihka_ret
    s_mov_b64 exec, 0
    s_bitcmp1_b32 s3, 1
    s_cbranch_scc1 L_ihs0_hi
    s_bitcmp1_b32 s3, 0
    s_cbranch_scc1 L_ihs0_1
    s_branch L_ihs0_0
L_ihs0_hi:
    s_bitcmp1_b32 s3, 0
    s_cbranch_scc1 L_ihs0_3
    s_branch L_ihs0_2
L_ihs0_ret:
    s_mov_b64 exec, -1
    s_waitcnt vmcnt(6)
    s_barrier
    ds_read_b64_tr_b16 v[96:97], v13 offset:0
    ds_read_b64_tr_b16 v[98:99], v14 offset:0
    ds_read_b128 v[128:131], v9 offset:0
    ds_read_b64_tr_b16 v[100:101], v15 offset:0
    ds_read_b64_tr_b16 v[102:103], v15 offset:512
    ds_read_b64_tr_b16 v[104:105], v13 offset:2080
    ds_read_b64_tr_b16 v[106:107], v14 offset:2080
    ds_read_b128 v[132:135], v10 offset:0
    ds_read_b64_tr_b16 v[108:109], v15 offset:2080
    ds_read_b64_tr_b16 v[110:111], v15 offset:2592
    s_waitcnt lgkmcnt(7)
    v_mfma_f32_32x32x16_bf16 v[32:47], v[96:99], v[128:131], 0
    s_add_u32 m0, s59, 16640
    s_nop 0
    buffer_load_dwordx4 v7, s[12:15], s60 offen lds
    v_dot2_f32_bf16 v88, v96, s64, v88
    v_dot2_f32_bf16 v89, v97, s64, v89
    v_dot2_f32_bf16 v88, v98, s64, v88
    v_dot2_f32_bf16 v89, v99, s64, v89
    s_waitcnt lgkmcnt(5)
    v_mfma_f32_32x32x16_bf16 v[48:63], v[100:103], v[128:131], 0
    ds_read_b64_tr_b16 v[112:113], v13 offset:4160
    ds_read_b64_tr_b16 v[114:115], v14 offset:4160
    ds_read_b128 v[136:139], v11 offset:0
    ds_read_b64_tr_b16 v[116:117], v15 offset:4160
    ds_read_b64_tr_b16 v[118:119], v15 offset:4672
    s_add_u32 m0, s59, 16640
    s_add_u32 s74, s60, 20464
    s_add_u32 s60, s60, 172032
    s_sub_u32 s62, s62, 1
    s_cmp_eq_u32 s62, 0
    s_cselect_b32 s60, s57, s60
    buffer_load_dwordx4 v7, s[12:15], s74 offen offset:1040 lds
    v_dot2_f32_bf16 v90, v100, s64, v90
    v_dot2_f32_bf16 v91, v101, s64, v91
    v_dot2_f32_bf16 v90, v102, s64, v90
    v_dot2_f32_bf16 v91, v103, s64, v91
    s_waitcnt lgkmcnt(7)
    v_mfma_f32_32x32x16_bf16 v[32:47], v[104:107], v[132:135], v[32:47]
    s_add_u32 m0, s58, 8192
    s_nop 0
    buffer_load_dwordx4 v5, s[8:11], s65 offen lds
    v_dot2_f32_bf16 v88, v104, s64, v88
    v_dot2_f32_bf16 v89, v105, s64, v89
    v_dot2_f32_bf16 v88, v106, s64, v88
    v_dot2_f32_bf16 v89, v107, s64, v89
    v_dot2_f32_bf16 v28, v128, v128, v28
    v_dot2_f32_bf16 v29, v129, v129, v29
    v_dot2_f32_bf16 v28, v130, v130, v28
    v_dot2_f32_bf16 v29, v131, v131, v29
    s_waitcnt lgkmcnt(5)
    v_mfma_f32_32x32x16_bf16 v[48:63], v[108:111], v[132:135], v[48:63]
    ds_read_b64_tr_b16 v[120:121], v13 offset:6240
    ds_read_b64_tr_b16 v[122:123], v14 offset:6240
    ds_read_b128 v[140:143], v12 offset:0
    ds_read_b64_tr_b16 v[124:125], v15 offset:6240
    ds_read_b64_tr_b16 v[126:127], v15 offset:6752
    s_add_u32 m0, s58, 8192
    s_add_u32 s74, s65, 6144
    buffer_load_dwordx4 v6, s[8:11], s74 offen offset:1024 lds
    s_add_u32 m0, s58, 8192
    s_add_u32 s74, s65, 12288
    buffer_load_dwordx4 v5, s[8:11], s74 offen offset:2048 lds
    v_dot2_f32_bf16 v90, v108, s64, v90
    v_dot2_f32_bf16 v91, v109, s64, v91
    v_dot2_f32_bf16 v90, v110, s64, v90
    v_dot2_f32_bf16 v91, v111, s64, v91
    s_waitcnt lgkmcnt(7)
    v_mfma_f32_32x32x16_bf16 v[32:47], v[112:115], v[136:139], v[32:47]
    s_add_u32 m0, s58, 8192
    s_add_u32 s74, s65, 18432
    s_add_u32 s65, s65, 128
    s_sub_u32 s55, s55, 1
    s_cmp_eq_u32 s55, 0
    s_cselect_b32 s65, s56, s65
    buffer_load_dwordx4 v6, s[8:11], s74 offen offset:3072 lds
    v_dot2_f32_bf16 v88, v112, s64, v88
    v_dot2_f32_bf16 v89, v113, s64, v89
    v_dot2_f32_bf16 v88, v114, s64, v88
    v_dot2_f32_bf16 v89, v115, s64, v89
    v_dot2_f32_bf16 v28, v132, v132, v28
    v_dot2_f32_bf16 v29, v133, v133, v29
    v_dot2_f32_bf16 v28, v134, v134, v28
    v_dot2_f32_bf16 v29, v135, v135, v29
    s_waitcnt lgkmcnt(5)
    v_mfma_f32_32x32x16_bf16 v[48:63], v[116:119], v[136:139], v[48:63]
    s_waitcnt vmcnt(6)
    s_barrier
    ds_read_b64_tr_b16 v[96:97], v13 offset:8320
    ds_read_b64_tr_b16 v[98:99], v14 offset:8320
    ds_read_b128 v[144:147], v9 offset:4096
    ds_read_b64_tr_b16 v[100:101], v15 offset:8320
    ds_read_b64_tr_b16 v[102:103], v15 offset:8832
    s_add_u32 m0, s59, 24960
    s_nop 0
    buffer_load_dwordx4 v7, s[12:15], s60 offen lds
    v_dot2_f32_bf16 v90, v116, s64, v90
    v_dot2_f32_bf16 v91, v117, s64, v91
    v_dot2_f32_bf16 v90, v118, s64, v90
    v_dot2_f32_bf16 v91, v119, s64, v91
    s_waitcnt lgkmcnt(7)
    v_mfma_f32_32x32x16_bf16 v[32:47], v[120:123], v[140:143], v[32:47]
    s_add_u32 m0, s59, 24960
    s_add_u32 s74, s60, 20464
    s_add_u32 s60, s60, 172032
    s_sub_u32 s62, s62, 1
    s_cmp_eq_u32 s62, 0
    s_cselect_b32 s60, s57, s60
    buffer_load_dwordx4 v7, s[12:15], s74 offen offset:1040 lds
    v_dot2_f32_bf16 v88, v120, s64, v88
    v_dot2_f32_bf16 v89, v121, s64, v89
    v_dot2_f32_bf16 v88, v122, s64, v88
    v_dot2_f32_bf16 v89, v123, s64, v89
    v_dot2_f32_bf16 v28, v136, v136, v28
    v_dot2_f32_bf16 v29, v137, v137, v29
    v_dot2_f32_bf16 v28, v138, v138, v28
    v_dot2_f32_bf16 v29, v139, v139, v29
    s_waitcnt lgkmcnt(5)
    v_mfma_f32_32x32x16_bf16 v[48:63], v[124:127], v[140:143], v[48:63]
    ds_read_b64_tr_b16 v[104:105], v13 offset:10400
    ds_read_b64_tr_b16 v[106:107], v14 offset:10400
    ds_read_b128 v[148:151], v10 offset:4096
    ds_read_b64_tr_b16 v[108:109], v15 offset:10400
    ds_read_b64_tr_b16 v[110:111], v15 offset:10912
    s_add_u32 m0, s58, 12288
    s_nop 0
    buffer_load_dwordx4 v5, s[8:11], s65 offen lds
    s_add_u32 m0, s58, 12288
    s_add_u32 s74, s65, 6144
    buffer_load_dwordx4 v6, s[8:11], s74 offen offset:1024 lds
    v_dot2_f32_bf16 v90, v124, s64, v90
    v_dot2_f32_bf16 v91, v125, s64, v91
    v_dot2_f32_bf16 v90, v126, s64, v90
    v_dot2_f32_bf16 v91, v127, s64, v91
    s_waitcnt lgkmcnt(7)
    v_mfma_f32_32x32x16_bf16 v[32:47], v[96:99], v[144:147], v[32:47]
    s_add_u32 m0, s58, 12288
    s_add_u32 s74, s65, 12288
    buffer_load_dwordx4 v5, s[8:11], s74 offen offset:2048 lds
    v_dot2_f32_bf16 v88, v96, s64, v88
    v_dot2_f32_bf16 v89, v97, s64, v89
    v_dot2_f32_bf16 v88, v98, s64, v88
    v_dot2_f32_bf16 v89, v99, s64, v89
    v_dot2_f32_bf16 v28, v140, v140, v28
    v_dot2_f32_bf16 v29, v141, v141, v29
    v_dot2_f32_bf16 v28, v142, v142, v28
    v_dot2_f32_bf16 v29, v143, v143, v29
    s_waitcnt lgkmcnt(5)
    v_mfma_f32_32x32x16_bf16 v[48:63], v[100:103], v[144:147], v[48:63]
    ds_read_b64_tr_b16 v[112:113], v13 offset:12480
    ds_read_b64_tr_b16 v[114:115], v14 offset:12480
    ds_read_b128 v[152:155], v11 offset:4096
    ds_read_b64_tr_b16 v[116:117], v15 offset:12480
    ds_read_b64_tr_b16 v[118:119], v15 offset:12992
    s_add_u32 m0, s58, 12288
    s_add_u32 s74, s65, 18432
    s_add_u32 s65, s65, 128
    s_sub_u32 s55, s55, 1
    s_cmp_eq_u32 s55, 0
    s_cselect_b32 s65, s56, s65
    buffer_load_dwordx4 v6, s[8:11], s74 offen offset:3072 lds
    v_dot2_f32_bf16 v90, v100, s64, v90
    v_dot2_f32_bf16 v91, v101, s64, v91
    v_dot2_f32_bf16 v90, v102, s64, v90
    v_dot2_f32_bf16 v91, v103, s64, v91
    s_waitcnt lgkmcnt(7)
    v_mfma_f32_32x32x16_bf16 v[32:47], v[104:107], v[148:151], v[32:47]
    buffer_store_dwordx4 v[252:255], v1, s[48:51], s96 offen
    v_dot2_f32_bf16 v88, v104, s64, v88
    v_dot2_f32_bf16 v89, v105, s64, v89
    v_dot2_f32_bf16 v88, v106, s64, v88
    v_dot2_f32_bf16 v89, v107, s64, v89
    v_dot2_f32_bf16 v28, v144, v144, v28
    v_dot2_f32_bf16 v29, v145, v145, v29
    v_dot2_f32_bf16 v28, v146, v146, v28
    v_dot2_f32_bf16 v29, v147, v147, v29
    s_waitcnt lgkmcnt(5)
    v_mfma_f32_32x32x16_bf16 v[48:63], v[108:111], v[148:151], v[48:63]
    ds_read_b64_tr_b16 v[120:121], v13 offset:14560
    ds_read_b64_tr_b16 v[122:123], v14 offset:14560
    ds_read_b128 v[156:159], v12 offset:4096
    ds_read_b64_tr_b16 v[124:125], v15 offset:14560
    ds_read_b64_tr_b16 v[126:127], v15 offset:15072
    buffer_store_dwordx4 v[252:255], v1, s[48:51], s96 offen offset:1024
    v_dot2_f32_bf16 v90, v108, s64, v90
    v_dot2_f32_bf16 v91, v109, s64, v91
    v_dot2_f32_bf16 v90, v110, s64, v90
    v_dot2_f32_bf16 v91, v111, s64, v91
    s_waitcnt lgkmcnt(7)
    v_mfma_f32_32x32x16_bf16 v[32:47], v[112:115], v[152:155], v[32:47]
    buffer_store_dwordx4 v[252:255], v1, s[48:51], s96 offen offset:2048
    v_dot2_f32_bf16 v88, v112, s64, v88
    v_dot2_f32_bf16 v89, v113, s64, v89
    v_dot2_f32_bf16 v88, v114, s64, v88
    v_dot2_f32_bf16 v89, v115, s64, v89
    v_dot2_f32_bf16 v28, v148, v148, v28
    v_dot2_f32_bf16 v29, v149, v149, v29
    v_dot2_f32_bf16 v28, v150, v150, v28
    v_dot2_f32_bf16 v29, v151, v151, v29
    s_waitcnt lgkmcnt(5)
    v_mfma_f32_32x32x16_bf16 v[48:63], v[116:119], v[152:155], v[48:63]
    s_waitcnt vmcnt(9)
    s_barrier
    ds_read_b64_tr_b16 v[96:97], v13 offset:16640
    ds_read_b64_tr_b16 v[98:99], v14 offset:16640
    ds_read_b128 v[160:163], v9 offset:8192
    ds_read_b64_tr_b16 v[100:101], v15 offset:16640
    ds_read_b64_tr_b16 v[102:103], v15 offset:17152
    buffer_store_dwordx4 v[252:255], v1, s[48:51], s96 offen offset:3072
    v_dot2_f32_bf16 v90, v116, s64, v90
    v_dot2_f32_bf16 v91, v117, s64, v91
    v_dot2_f32_bf16 v90, v118, s64, v90
    v_dot2_f32_bf16 v91, v119, s64, v91
    s_waitcnt lgkmcnt(7)
    v_mfma_f32_32x32x16_bf16 v[32:47], v[120:123], v[156:159], v[32:47]
    s_mov_b64 exec, 15
    buffer_store_dwordx4 v[252:255], v1, s[48:51], s54 offen sc1
    s_mov_b64 exec, -1
    v_dot2_f32_bf16 v88, v120, s64, v88
    v_dot2_f32_bf16 v89, v121, s64, v89
    v_dot2_f32_bf16 v88, v122, s64, v88
    v_dot2_f32_bf16 v89, v123, s64, v89
    v_dot2_f32_bf16 v28, v152, v152, v28
    v_dot2_f32_bf16 v29, v153, v153, v29
    v_dot2_f32_bf16 v28, v154, v154, v28
    v_dot2_f32_bf16 v29, v155, v155, v29
    s_waitcnt lgkmcnt(5)
    v_mfma_f32_32x32x16_bf16 v[48:63], v[124:127], v[156:159], v[48:63]
    ds_read_b64_tr_b16 v[104:105], v13 offset:18720
    ds_read_b64_tr_b16 v[106:107], v14 offset:18720
    ds_read_b128 v[164:167], v10 offset:8192
    ds_read_b64_tr_b16 v[108:109], v15 offset:18720
    ds_read_b64_tr_b16 v[110:111], v15 offset:19232
    s_lshl_b32 s74, s2, 2
    s_add_u32 s74, s74, s3
    s_mul_i32 s74, s74, 1664
    v_lshl_add_u32 v64, v0, 7, s74
    s_mov_b64 exec, 8191
    buffer_load_dword a255, v64, s[24:27], 0 offen
    s_mov_b64 exec, -1
    s_lshl_b32 s74, s2, 2
    s_add_u32 s74, s74, s3
    s_mul_i32 s74, s74, 1664
    v_lshl_add_u32 v64, v0, 7, s74
    s_mov_b64 exec, 8191
    buffer_load_dword a255, v64, s[32:35], 0 offen
    s_mov_b64 exec, -1
    v_dot2_f32_bf16 v90, v124, s64, v90
    v_dot2_f32_bf16 v91, v125, s64, v91
    v_dot2_f32_bf16 v90, v126, s64, v90
    v_dot2_f32_bf16 v91, v127, s64, v91
    s_waitcnt lgkmcnt(7)
    v_mfma_f32_32x32x16_bf16 v[32:47], v[96:99], v[160:163], v[32:47]
    s_mul_i32 s74, s5, 1568
    s_mul_i32 s94, s3, 400
    s_add_u32 s74, s74, s94
    s_add_u32 m0, s94, 158720
    s_mov_b64 exec, 0x1ffffff
    buffer_load_dwordx4 v1, s[16:19], s74 offen lds
    s_mov_b64 exec, -1
    v_dot2_f32_bf16 v88, v96, s64, v88
    v_dot2_f32_bf16 v89, v97, s64, v89
    v_dot2_f32_bf16 v88, v98, s64, v88
    v_dot2_f32_bf16 v89, v99, s64, v89
    v_dot2_f32_bf16 v28, v156, v156, v28
    v_dot2_f32_bf16 v29, v157, v157, v29
    v_dot2_f32_bf16 v28, v158, v158, v28
    v_dot2_f32_bf16 v29, v159, v159, v29
    s_waitcnt lgkmcnt(5)
    v_mfma_f32_32x32x16_bf16 v[48:63], v[100:103], v[160:163], v[48:63]
    ds_read_b64_tr_b16 v[112:113], v13 offset:20800
    ds_read_b64_tr_b16 v[114:115], v14 offset:20800
    ds_read_b128 v[168:171], v11 offset:8192
    ds_read_b64_tr_b16 v[116:117], v15 offset:20800
    ds_read_b64_tr_b16 v[118:119], v15 offset:21312
L_ihka_2:
    s_cbranch_execz L_ihka_ret
    s_add_u32 m0, s59, 33280
    s_nop 0
    buffer_load_dwordx4 v7, s[12:15], s60 offen lds
    v_dot2_f32_bf16 v90, v100, s64, v90
    v_dot2_f32_bf16 v91, v101, s64, v91
    v_dot2_f32_bf16 v90, v102, s64, v90
    v_dot2_f32_bf16 v91, v103, s64, v91
    s_waitcnt lgkmcnt(7)
    v_mfma_f32_32x32x16_bf16 v[32:47], v[104:107], v[164:167], v[32:47]
    s_add_u32 m0, s59, 33280
    s_add_u32 s74, s60, 20464
    s_add_u32 s60, s60, 172032
    s_sub_u32 s62, s62, 1
    s_cmp_eq_u32 s62, 0
    s_cselect_b32 s60, s57, s60
    buffer_load_dwordx4 v7, s[12:15], s74 offen offset:1040 lds
    v_dot2_f32_bf16 v88, v104, s64, v88
    v_dot2_f32_bf16 v89, v105, s64, v89
    v_dot2_f32_bf16 v88, v106, s64, v88
    v_dot2_f32_bf16 v89, v107, s64, v89
    v_dot2_f32_bf16 v28, v160, v160, v28
    v_dot2_f32_bf16 v29, v161, v161, v29
    v_dot2_f32_bf16 v28, v162, v162, v28
    v_dot2_f32_bf16 v29, v163, v163, v29
    s_waitcnt lgkmcnt(5)
    v_mfma_f32_32x32x16_bf16 v[48:63], v[108:111], v[164:167], v[48:63]
    ds_read_b64_tr_b16 v[120:121], v13 offset:22880
    ds_read_b64_tr_b16 v[122:123], v14 offset:22880
    ds_read_b128 v[172:175], v12 offset:8192
    ds_read_b64_tr_b16 v[124:125], v15 offset:22880
    ds_read_b64_tr_b16 v[126:127], v15 offset:23392
    s_add_u32 m0, s58, 0
    s_nop 0
    buffer_load_dwordx4 v5, s[8:11], s65 offen lds
    v_dot2_f32_bf16 v90, v108, s64, v90
    v_dot2_f32_bf16 v91, v109, s64, v91
    v_dot2_f32_bf16 v90, v110, s64, v90
    v_dot2_f32_bf16 v91, v111, s64, v91
    s_waitcnt lgkmcnt(7)
    v_mfma_f32_32x32x16_bf16 v[32:47], v[112:115], v[168:171], v[32:47]
    s_add_u32 m0, s58, 0
    s_add_u32 s74, s65, 6144
    buffer_load_dwordx4 v6, s[8:11], s74 offen offset:1024 lds
    v_dot2_f32_bf16 v88, v112, s64, v88
    v_dot2_f32_bf16 v89, v113, s64, v89
    v_dot2_f32_bf16 v88, v114, s64, v88
    v_dot2_f32_bf16 v89, v115, s64, v89
    v_dot2_f32_bf16 v28, v164, v164, v28
    v_dot2_f32_bf16 v29, v165, v165, v29
    v_dot2_f32_bf16 v28, v166, v166, v28
    v_dot2_f32_bf16 v29, v167, v167, v29
    s_waitcnt lgkmcnt(5)
    v_mfma_f32_32x32x16_bf16 v[48:63], v[116:119], v[168:171], v[48:63]
    s_waitcnt vmcnt(12)
    s_barrier
    ds_read_b64_tr_b16 v[96:97], v13 offset:24960
    ds_read_b64_tr_b16 v[98:99], v14 offset:24960
    ds_read_b128 v[176:179], v9 offset:12288
    ds_read_b64_tr_b16 v[100:101], v15 offset:24960
    ds_read_b64_tr_b16 v[102:103], v15 offset:25472
    s_add_u32 m0, s58, 0
    s_add_u32 s74, s65, 12288
    buffer_load_dwordx4 v5, s[8:11], s74 offen offset:2048 lds
    v_dot2_f32_bf16 v90, v116, s64, v90
    v_dot2_f32_bf16 v91, v117, s64, v91
    v_dot2_f32_bf16 v90, v118, s64, v90
    v_dot2_f32_bf16 v91, v119, s64, v91
    s_waitcnt lgkmcnt(7)
    v_mfma_f32_32x32x16_bf16 v[32:47], v[120:123], v[172:175], v[32:47]
    s_add_u32 m0, s58, 0
    s_add_u32 s74, s65, 18432
    s_add_u32 s65, s65, 128
    s_sub_u32 s55, s55, 1
    s_cmp_eq_u32 s55, 0
    s_cselect_b32 s65, s56, s65
    buffer_load_dwordx4 v6, s[8:11], s74 offen offset:3072 lds
    v_dot2_f32_bf16 v88, v120, s64, v88
    v_dot2_f32_bf16 v89, v121, s64, v89
    v_dot2_f32_bf16 v88, v122, s64, v88
    v_dot2_f32_bf16 v89, v123, s64, v89
    v_dot2_f32_bf16 v28, v168, v168, v28
    v_dot2_f32_bf16 v29, v169, v169, v29
    v_dot2_f32_bf16 v28, v170, v170, v28
    v_dot2_f32_bf16 v29, v171, v171, v29
    s_waitcnt lgkmcnt(5)
    v_mfma_f32_32x32x16_bf16 v[48:63], v[124:127], v[172:175], v[48:63]
    ds_read_b64_tr_b16 v[104:105], v13 offset:27040
    ds_read_b64_tr_b16 v[106:107], v14 offset:27040
    ds_read_b128 v[180:183], v10 offset:12288
    ds_read_b64_tr_b16 v[108:109], v15 offset:27040
    ds_read_b64_tr_b16 v[110:111], v15 offset:27552
    s_add_u32 m0, s59, 41600
    s_nop 0
    buffer_load_dwordx4 v7, s[12:15], s60 offen lds
    s_add_u32 m0, s59, 41600
    s_add_u32 s74, s60, 20464
    s_add_u32 s60, s60, 172032
    s_sub_u32 s62, s62, 1
    s_cmp_eq_u32 s62, 0
    s_cselect_b32 s60, s57, s60
    buffer_load_dwordx4 v7, s[12:15], s74 offen offset:1040 lds
    v_dot2_f32_bf16 v90, v124, s64, v90
    v_dot2_f32_bf16 v91, v125, s64, v91
    v_dot2_f32_bf16 v90, v126, s64, v90
    v_dot2_f32_bf16 v91, v127, s64, v91
    s_waitcnt lgkmcnt(7)
    v_mfma_f32_32x32x16_bf16 v[32:47], v[96:99], v[176:179], v[32:47]
    s_add_u32 m0, s58, 4096
    s_nop 0
    buffer_load_dwordx4 v5, s[8:11], s65 offen lds
    v_dot2_f32_bf16 v88, v96, s64, v88
    v_dot2_f32_bf16 v89, v97, s64, v89
    v_dot2_f32_bf16 v88, v98, s64, v88
    v_dot2_f32_bf16 v89, v99, s64, v89
    v_dot2_f32_bf16 v28, v172, v172, v28
    v_dot2_f32_bf16 v29, v173, v173, v29
    v_dot2_f32_bf16 v28, v174, v174, v28
    v_dot2_f32_bf16 v29, v175, v175, v29
    s_waitcnt lgkmcnt(5)
    v_mfma_f32_32x32x16_bf16 v[48:63], v[100:103], v[176:179], v[48:63]
    ds_read_b64_tr_b16 v[112:113], v13 offset:29120
    ds_read_b64_tr_b16 v[114:115], v14 offset:29120
    ds_read_b128 v[184:187], v11 offset:12288
    ds_read_b64_tr_b16 v[116:117], v15 offset:29120
    ds_read_b64_tr_b16 v[118:119], v15 offset:29632
    s_add_u32 m0, s58, 4096
    s_add_u32 s74, s65, 6144
    buffer_load_dwordx4 v6, s[8:11], s74 offen offset:1024 lds
    v_dot2_f32_bf16 v90, v100, s64, v90
    v_dot2_f32_bf16 v91, v101, s64, v91
    v_dot2_f32_bf16 v90, v102, s64, v90
    v_dot2_f32_bf16 v91, v103, s64, v91
    s_waitcnt lgkmcnt(7)
    v_mfma_f32_32x32x16_bf16 v[32:47], v[104:107], v[180:183], v[32:47]
    s_add_u32 m0, s58, 4096
    s_add_u32 s74, s65, 12288
    buffer_load_dwordx4 v5, s[8:11], s74 offen offset:2048 lds
    v_dot2_f32_bf16 v88, v104, s64, v88
    v_dot2_f32_bf16 v89, v105, s64, v89
    v_dot2_f32_bf16 v88, v106, s64, v88
    v_dot2_f32_bf16 v89, v107, s64, v89
    v_dot2_f32_bf16 v28, v176, v176, v28
    v_dot2_f32_bf16 v29, v177, v177, v29
    v_dot2_f32_bf16 v28, v178, v178, v28
    v_dot2_f32_bf16 v29, v179, v179, v29
    s_waitcnt lgkmcnt(5)
    v_mfma_f32_32x32x16_bf16 v[48:63], v[108:111], v[180:183], v[48:63]
    ds_read_b64_tr_b16 v[120:121], v13 offset:31200
    ds_read_b64_tr_b16 v[122:123], v14 offset:31200
    ds_read_b128 v[188:191], v12 offset:12288
    ds_read_b64_tr_b16 v[124:125], v15 offset:31200
    ds_read_b64_tr_b16 v[126:127], v15 offset:31712
    s_add_u32 m0, s58, 4096
    s_add_u32 s74, s65, 18432
    s_add_u32 s65, s65, 128
    s_sub_u32 s55, s55, 1
    s_cmp_eq_u32 s55, 0
    s_cselect_b32 s65, s56, s65
    buffer_load_dwordx4 v6, s[8:11], s74 offen offset:3072 lds
    v_dot2_f32_bf16 v90, v108, s64, v90
    v_dot2_f32_bf16 v91, v109, s64, v91
    v_dot2_f32_bf16 v90, v110, s64, v90
    v_dot2_f32_bf16 v91, v111, s64, v91
    s_waitcnt lgkmcnt(7)
    v_mfma_f32_32x32x16_bf16 v[32:47], v[112:115], v[184:187], v[32:47]
    s_add_u32 m0, s59, 49920
    s_nop 0
    buffer_load_dwordx4 v7, s[12:15], s60 offen lds
    v_dot2_f32_bf16 v88, v112, s64, v88
    v_dot2_f32_bf16 v89, v113, s64, v89
    v_dot2_f32_bf16 v88, v114, s64, v88
    v_dot2_f32_bf16 v89, v115, s64, v89
    v_dot2_f32_bf16 v28, v180, v180, v28
    v_dot2_f32_bf16 v29, v181, v181, v29
    v_dot2_f32_bf16 v28, v182, v182, v28
    v_dot2_f32_bf16 v29, v183, v183, v29
    s_waitcnt lgkmcnt(5)
    v_mfma_f32_32x32x16_bf16 v[48:63], v[116:119], v[184:187], v[48:63]
    s_waitcnt vmcnt(7)
    s_barrier
    ds_read_b64_tr_b16 v[96:97], v13 offset:33280
    ds_read_b64_tr_b16 v[98:99], v14 offset:33280
    ds_read_b128 v[192:195], v9 offset:0
    ds_read_b64_tr_b16 v[100:101], v15 offset:33280
    ds_read_b64_tr_b16 v[102:103], v15 offset:33792
    s_add_u32 m0, s59, 49920
    s_add_u32 s74, s60, 20464
    buffer_load_dwordx4 v7, s[12:15], s74 offen offset:1040 lds
    v_dot2_f32_bf16 v90, v116, s64, v90
    v_dot2_f32_bf16 v91, v117, s64, v91
    v_dot2_f32_bf16 v90, v118, s64, v90
    v_dot2_f32_bf16 v91, v119, s64, v91
    s_waitcnt lgkmcnt(7)
    v_mfma_f32_32x32x16_bf16 v[32:47], v[120:123], v[188:191], v[32:47]
    s_add_u32 m0, s58, 8192
    s_nop 0
    buffer_load_dwordx4 v5, s[8:11], s65 offen lds
    v_dot2_f32_bf16 v88, v120, s64, v88
    v_dot2_f32_bf16 v89, v121, s64, v89
    v_dot2_f32_bf16 v88, v122, s64, v88
    v_dot2_f32_bf16 v89, v123, s64, v89
    v_dot2_f32_bf16 v28, v184, v184, v28
    v_dot2_f32_bf16 v29, v185, v185, v29
    v_dot2_f32_bf16 v28, v186, v186, v28
    v_dot2_f32_bf16 v29, v187, v187, v29
    s_waitcnt lgkmcnt(5)
    v_mfma_f32_32x32x16_bf16 v[48:63], v[124:127], v[188:191], v[48:63]
    ds_read_b64_tr_b16 v[104:105], v13 offset:35360
    ds_read_b64_tr_b16 v[106:107], v14 offset:35360
    ds_read_b128 v[196:199], v10 offset:0
    ds_read_b64_tr_b16 v[108:109], v15 offset:35360
    ds_read_b64_tr_b16 v[110:111], v15 offset:35872
    s_add_u32 m0, s58, 8192
    s_add_u32 s74, s65, 6144
    buffer_load_dwordx4 v6, s[8:11], s74 offen offset:1024 lds
    v_dot2_f32_bf16 v90, v124, s64, v90
    v_dot2_f32_bf16 v91, v125, s64, v91
    v_dot2_f32_bf16 v90, v126, s64, v90
    v_dot2_f32_bf16 v91, v127, s64, v91
    s_waitcnt lgkmcnt(7)
    v_mfma_f32_32x32x16_bf16 v[32:47], v[96:99], v[192:195], v[32:47]
    s_add_u32 m0, s58, 8192
    s_add_u32 s74, s65, 12288
    buffer_load_dwordx4 v5, s[8:11], s74 offen offset:2048 lds
    v_dot2_f32_bf16 v88, v96, s64, v88
    v_dot2_f32_bf16 v89, v97, s64, v89
    v_dot2_f32_bf16 v88, v98, s64, v88
    v_dot2_f32_bf16 v89, v99, s64, v89
    v_dot2_f32_bf16 v28, v188, v188, v28
    v_dot2_f32_bf16 v29, v189, v189, v29
    v_dot2_f32_bf16 v28, v190, v190, v28
    v_dot2_f32_bf16 v29, v191, v191, v29
    s_waitcnt lgkmcnt(5)
    v_mfma_f32_32x32x16_bf16 v[48:63], v[100:103], v[192:195], v[48:63]
    ds_read_b64_tr_b16 v[112:113], v13 offset:37440
    ds_read_b64_tr_b16 v[114:115], v14 offset:37440
    ds_read_b128 v[200:203], v11 offset:0
    ds_read_b64_tr_b16 v[116:117], v15 offset:37440
    ds_read_b64_tr_b16 v[118:119], v15 offset:37952
    s_add_u32 m0, s58, 8192
    s_add_u32 s74, s65, 18432
    buffer_load_dwordx4 v6, s[8:11], s74 offen offset:3072 lds
    v_dot2_f32_bf16 v90, v100, s64, v90
    v_dot2_f32_bf16 v91, v101, s64, v91
    v_dot2_f32_bf16 v90, v102, s64, v90
    v_dot2_f32_bf16 v91, v103, s64, v91
    s_waitcnt lgkmcnt(7)
    v_mfma_f32_32x32x16_bf16 v[32:47], v[104:107], v[196:199], v[32:47]
    s_mov_b64 exec, 268435455
    s_min_u32 s74, s98, 111
    s_mul_i32 s74, s74, 10752
    buffer_load_dword a255, v65, s[12:15], s74 offen
    s_mov_b64 exec, -1
    v_dot2_f32_bf16 v88, v104, s64, v88
    v_dot2_f32_bf16 v89, v105, s64, v89
    v_dot2_f32_bf16 v88, v106, s64, v88
    v_dot2_f32_bf16 v89, v107, s64, v89
    v_dot2_f32_bf16 v28, v192, v192, v28
    v_dot2_f32_bf16 v29, v193, v193, v29
    v_dot2_f32_bf16 v28, v194, v194, v28
    v_dot2_f32_bf16 v29, v195, v195, v29
    s_waitcnt lgkmcnt(5)
    v_mfma_f32_32x32x16_bf16 v[48:63], v[108:111], v[196:199], v[48:63]
    ds_read_b64_tr_b16 v[120:121], v13 offset:39520
    ds_read_b64_tr_b16 v[122:123], v14 offset:39520
    ds_read_b128 v[204:207], v12 offset:0
    ds_read_b64_tr_b16 v[124:125], v15 offset:39520
    ds_read_b64_tr_b16 v[126:127], v15 offset:40032
    buffer_load_dwordx2 v[250:251], off, s[44:47], 0 sc1
    v_dot2_f32_bf16 v90, v108, s64, v90
    v_dot2_f32_bf16 v91, v109, s64, v91
    v_dot2_f32_bf16 v90, v110, s64, v90
    v_dot2_f32_bf16 v91, v111, s64, v91
    s_waitcnt lgkmcnt(7)
    v_mfma_f32_32x32x16_bf16 v[32:47], v[112:115], v[200:203], v[32:47]
    s_mul_i32 s52, s3, 7
    s_lshl_b32 s94, s99, 2
    s_add_u32 s52, s52, s94
    s_mul_i32 s53, s3, 7168
    s_sub_u32 s94, s52, 28
    s_cmp_ge_u32 s52, 28
    s_cselect_b32 s52, s94, s52
    s_mul_i32 s74, s52, 43008
    s_add_u32 s74, s74, s72
    s_add_u32 m0, s53, 123904
    s_nop 0
    buffer_load_dwordx4 v8, s[12:15], s74 offen lds
    v_dot2_f32_bf16 v88, v112, s64, v88
    v_dot2_f32_bf16 v89, v113, s64, v89
    v_dot2_f32_bf16 v88, v114, s64, v88
    v_dot2_f32_bf16 v89, v115, s64, v89
    v_dot2_f32_bf16 v28, v196, v196, v28
    v_dot2_f32_bf16 v29, v197, v197, v29
    v_dot2_f32_bf16 v28, v198, v198, v28
    v_dot2_f32_bf16 v29, v199, v199, v29
    s_waitcnt lgkmcnt(5)
    v_mfma_f32_32x32x16_bf16 v[48:63], v[116:119], v[200:203], v[48:63]
    s_waitcnt vmcnt(9)
    s_barrier
    ds_read_b64_tr_b16 v[96:97], v13 offset:41600
    ds_read_b64_tr_b16 v[98:99], v14 offset:41600
    ds_read_b128 v[208:211], v9 offset:4096
    ds_read_b64_tr_b16 v[100:101], v15 offset:41600
    ds_read_b64_tr_b16 v[102:103], v15 offset:42112
    s_add_u32 s52, s52, 1
    s_sub_u32 s94, s52, 28
    s_cmp_ge_u32 s52, 28
    s_cselect_b32 s52, s94, s52
    s_mul_i32 s74, s52, 43008
    s_add_u32 s74, s74, s72
    s_add_u32 m0, s53, 124928
    s_nop 0
    buffer_load_dwordx4 v8, s[12:15], s74 offen lds
    v_dot2_f32_bf16 v90, v116, s64, v90
    v_dot2_f32_bf16 v91, v117, s64, v91
    v_dot2_f32_bf16 v90, v118, s64, v90
    v_dot2_f32_bf16 v91, v119, s64, v91
    s_waitcnt lgkmcnt(7)
    v_mfma_f32_32x32x16_bf16 v[32:47], v[120:123], v[204:207], v[32:47]
    s_add_u32 s52, s52, 1
    s_sub_u32 s94, s52, 28
    s_cmp_ge_u32 s52, 28
    s_cselect_b32 s52, s94, s52
    s_mul_i32 s74, s52, 43008
    s_add_u32 s74, s74, s72
    s_add_u32 m0, s53, 125952
    s_nop 0
    buffer_load_dwordx4 v8, s[12:15], s74 offen lds
    v_dot2_f32_bf16 v88, v120, s64, v88
    v_dot2_f32_bf16 v89, v121, s64, v89
    v_dot2_f32_bf16 v88, v122, s64, v88
    v_dot2_f32_bf16 v89, v123, s64, v89
    v_dot2_f32_bf16 v28, v200, v200, v28
    v_dot2_f32_bf16 v29, v201, v201, v29
    v_dot2_f32_bf16 v28, v202, v202, v28
    v_dot2_f32_bf16 v29, v203, v203, v29
    s_waitcnt lgkmcnt(5)
    v_mfma_f32_32x32x16_bf16 v[48:63], v[124:127], v[204:207], v[48:63]
    ds_read_b64_tr_b16 v[104:105], v13 offset:43680
    ds_read_b64_tr_b16 v[106:107], v14 offset:43680
    ds_read_b128 v[212:215], v10 offset:4096
    ds_read_b64_tr_b16 v[108:109], v15 offset:43680
    ds_read_b64_tr_b16 v[110:111], v15 offset:44192
    s_add_u32 s52, s52, 1
    s_sub_u32 s94, s52, 28
    s_cmp_ge_u32 s52, 28
    s_cselect_b32 s52, s94, s52
    s_mul_i32 s74, s52, 43008
    s_add_u32 s74, s74, s72
    s_add_u32 m0, s53, 126976
    s_nop 0
    buffer_load_dwordx4 v8, s[12:15], s74 offen lds
    v_dot2_f32_bf16 v90, v124, s64, v90
    v_dot2_f32_bf16 v91, v125, s64, v91
    v_dot2_f32_bf16 v90, v126, s64, v90
    v_dot2_f32_bf16 v91, v127, s64, v91
    s_waitcnt lgkmcnt(7)
    v_mfma_f32_32x32x16_bf16 v[32:47], v[96:99], v[208:211], v[32:47]
    v_dot2_f32_bf16 v88, v96, s64, v88
    v_dot2_f32_bf16 v89, v97, s64, v89
    v_dot2_f32_bf16 v88, v98, s64, v88
    v_dot2_f32_bf16 v89, v99, s64, v89
    v_dot2_f32_bf16 v28, v204, v204, v28
    v_dot2_f32_bf16 v29, v205, v205, v29
    v_dot2_f32_bf16 v28, v206, v206, v28
    v_dot2_f32_bf16 v29, v207, v207, v29
    s_waitcnt lgkmcnt(5)
    v_mfma_f32_32x32x16_bf16 v[48:63], v[100:103], v[208:211], v[48:63]
    ds_read_b64_tr_b16 v[112:113], v13 offset:45760
    ds_read_b64_tr_b16 v[114:115], v14 offset:45760
    ds_read_b128 v[216:219], v11 offset:4096
    ds_read_b64_tr_b16 v[116:117], v15 offset:45760
    ds_read_b64_tr_b16 v[118:119], v15 offset:46272
    s_add_u32 s52, s52, 1
    s_sub_u32 s94, s52, 28
    s_cmp_ge_u32 s52, 28
    s_cselect_b32 s52, s94, s52
    s_mul_i32 s74, s52, 43008
    s_add_u32 s74, s74, s72
    s_add_u32 m0, s53, 128000
    s_nop 0
    buffer_load_dwordx4 v8, s[12:15], s74 offen lds
    v_dot2_f32_bf16 v90, v100, s64, v90
    v_dot2_f32_bf16 v91, v101, s64, v91
    v_dot2_f32_bf16 v90, v102, s64, v90
    v_dot2_f32_bf16 v91, v103, s64, v91
    s_waitcnt lgkmcnt(7)
    v_mfma_f32_32x32x16_bf16 v[32:47], v[104:107], v[212:215], v[32:47]
    v_dot2_f32_bf16 v88, v104, s64, v88
    v_dot2_f32_bf16 v89, v105, s64, v89
    v_dot2_f32_bf16 v88, v106, s64, v88
    v_dot2_f32_bf16 v89, v107, s64, v89
    v_dot2_f32_bf16 v28, v208, v208, v28
    v_dot2_f32_bf16 v29, v209, v209, v29
    v_dot2_f32_bf16 v28, v210, v210, v28
    v_dot2_f32_bf16 v29, v211, v211, v29
    s_waitcnt lgkmcnt(5)
    v_mfma_f32_32x32x16_bf16 v[48:63], v[108:111], v[212:215], v[48:63]
    ds_read_b64_tr_b16 v[120:121], v13 offset:47840
    ds_read_b64_tr_b16 v[122:123], v14 offset:47840
    ds_read_b128 v[220:223], v12 offset:4096
    ds_read_b64_tr_b16 v[124:125], v15 offset:47840
    ds_read_b64_tr_b16 v[126:127], v15 offset:48352
    s_add_u32 s52, s52, 1
    s_sub_u32 s94, s52, 28
    s_cmp_ge_u32 s52, 28
    s_cselect_b32 s52, s94, s52
    s_mul_i32 s74, s52, 43008
    s_add_u32 s74, s74, s72
    s_add_u32 m0, s53, 129024
    s_nop 0
    buffer_load_dwordx4 v8, s[12:15], s74 offen lds
    v_dot2_f32_bf16 v90, v108, s64, v90
    v_dot2_f32_bf16 v91, v109, s64, v91
    v_dot2_f32_bf16 v90, v110, s64, v90
    v_dot2_f32_bf16 v91, v111, s64, v91
    s_waitcnt lgkmcnt(7)
    v_mfma_f32_32x32x16_bf16 v[32:47], v[112:115], v[216:219], v[32:47]
    s_add_u32 s52, s52, 1
    s_sub_u32 s94, s52, 28
    s_cmp_ge_u32 s52, 28
    s_cselect_b32 s52, s94, s52
    s_mul_i32 s74, s52, 43008
    s_add_u32 s74, s74, s72
    s_add_u32 m0, s53, 130048
    s_nop 0
    buffer_load_dwordx4 v8, s[12:15], s74 offen lds
    v_dot2_f32_bf16 v88, v112, s64, v88
    v_dot2_f32_bf16 v89, v113, s64, v89
    v_dot2_f32_bf16 v88, v114, s64, v88
    v_dot2_f32_bf16 v89, v115, s64, v89
    v_dot2_f32_bf16 v28, v212, v212, v28
    v_dot2_f32_bf16 v29, v213, v213, v29
    v_dot2_f32_bf16 v28, v214, v214, v28
L_ihs0_0:
    s_cbranch_execz L_ihs0_ret
    v_dot2_f32_bf16 v29, v215, v215, v29
    s_waitcnt lgkmcnt(5)
    v_mfma_f32_32x32x16_bf16 v[48:63], v[116:119], v[216:219], v[48:63]
    s_waitcnt vmcnt(9)
    s_barrier
    ds_read_b64_tr_b16 v[96:97], v13 offset:49920
    ds_read_b64_tr_b16 v[98:99], v14 offset:49920
    ds_read_b128 v[224:227], v9 offset:8192
    ds_read_b64_tr_b16 v[100:101], v15 offset:49920
    ds_read_b64_tr_b16 v[102:103], v15 offset:50432
    v_dot2_f32_bf16 v90, v116, s64, v90
    v_dot2_f32_bf16 v91, v117, s64, v91
    v_dot2_f32_bf16 v90, v118, s64, v90
    v_dot2_f32_bf16 v91, v119, s64, v91
    s_waitcnt lgkmcnt(7)
    v_mfma_f32_32x32x16_bf16 v[32:47], v[120:123], v[220:223], v[32:47]
    s_mov_b64 exec, 33554431
    s_mul_i32 s74, s98, 3200
    s_add_u32 s74, s74, 0
    buffer_load_dword a255, v20, s[20:23], s74 offen
    s_mov_b64 exec, -1
    v_dot2_f32_bf16 v88, v120, s64, v88
    v_dot2_f32_bf16 v89, v121, s64, v89
    v_dot2_f32_bf16 v88, v122, s64, v88
    v_dot2_f32_bf16 v89, v123, s64, v89
    v_dot2_f32_bf16 v28, v216, v216, v28
    v_dot2_f32_bf16 v29, v217, v217, v29
    v_dot2_f32_bf16 v28, v218, v218, v28
    v_dot2_f32_bf16 v29, v219, v219, v29
    s_waitcnt lgkmcnt(5)
    v_mfma_f32_32x32x16_bf16 v[48:63], v[124:127], v[220:223], v[48:63]
    ds_read_b64_tr_b16 v[104:105], v13 offset:52000
    ds_read_b64_tr_b16 v[106:107], v14 offset:52000
    ds_read_b128 v[228:231], v10 offset:8192
    ds_read_b64_tr_b16 v[108:109], v15 offset:52000
    ds_read_b64_tr_b16 v[110:111], v15 offset:52512
    s_mov_b32 exec_hi, 0
    buffer_load_dword a255, v20, s[48:51], s96 offen
    s_mov_b32 exec_hi, -1
    v_dot2_f32_bf16 v90, v124, s64, v90
    v_dot2_f32_bf16 v91, v125, s64, v91
    v_dot2_f32_bf16 v90, v126, s64, v90
    v_dot2_f32_bf16 v91, v127, s64, v91
    ds_read_b64_tr_b16 v[112:113], v13 offset:54080
    ds_read_b64_tr_b16 v[114:115], v14 offset:54080
    ds_read_b128 v[232:235], v11 offset:8192
    ds_read_b64_tr_b16 v[116:117], v15 offset:54080
    ds_read_b64_tr_b16 v[118:119], v15 offset:54592
    ds_read_b64_tr_b16 v[120:121], v13 offset:56160
    ds_read_b64_tr_b16 v[122:123], v14 offset:56160
    ds_read_b128 v[236:239], v12 offset:8192
    ds_read_b64_tr_b16 v[124:125], v15 offset:56160
    ds_read_b64_tr_b16 v[126:127], v15 offset:56672
    ds_read_b64_tr_b16 v[80:81], v26
    ds_read_b64_tr_b16 v[82:83], v26 offset:448
    ds_read_b64_tr_b16 v[84:85], v26 offset:896
    ds_read_b64_tr_b16 v[86:87], v27
    v_dot2_f32_bf16 v28, v220, v220, v28
    v_dot2_f32_bf16 v29, v221, v221, v29
    v_dot2_f32_bf16 v28, v222, v222, v28
    v_dot2_f32_bf16 v29, v223, v223, v29
    s_waitcnt lgkmcnt(15)
    v_mfma_f32_32x32x16_bf16 v[32:47], v[96:99], v[224:227], v[32:47]
    v_dot2_f32_bf16 v88, v96, s64, v88
    v_dot2_f32_bf16 v89, v97, s64, v89
    v_dot2_f32_bf16 v88, v98, s64, v88
    v_dot2_f32_bf16 v89, v99, s64, v89
    v_dot2_f32_bf16 v28, v224, v224, v28
    v_dot2_f32_bf16 v29, v225, v225, v29
    v_dot2_f32_bf16 v28, v226, v226, v28
    v_dot2_f32_bf16 v29, v227, v227, v29
    v_mfma_f32_32x32x16_bf16 v[32:47], v[104:107], v[228:231], v[32:47]
    v_dot2_f32_bf16 v88, v104, s64, v88
    v_dot2_f32_bf16 v89, v105, s64, v89
    v_dot2_f32_bf16 v88, v106, s64, v88
    v_dot2_f32_bf16 v89, v107, s64, v89
    v_dot2_f32_bf16 v28, v228, v228, v28
    v_dot2_f32_bf16 v29, v229, v229, v29
    v_dot2_f32_bf16 v28, v230, v230, v28
    v_dot2_f32_bf16 v29, v231, v231, v29
    s_waitcnt lgkmcnt(11)
    v_mfma_f32_32x32x16_bf16 v[32:47], v[112:115], v[232:235], v[32:47]
    v_dot2_f32_bf16 v88, v112, s64, v88
    v_dot2_f32_bf16 v89, v113, s64, v89
    v_dot2_f32_bf16 v88, v114, s64, v88
    v_dot2_f32_bf16 v89, v115, s64, v89
    v_dot2_f32_bf16 v28, v232, v232, v28
    v_dot2_f32_bf16 v29, v233, v233, v29
    v_dot2_f32_bf16 v28, v234, v234, v28
    v_dot2_f32_bf16 v29, v235, v235, v29
    s_waitcnt lgkmcnt(6)
    v_mfma_f32_32x32x16_bf16 v[32:47], v[120:123], v[236:239], v[32:47]
    v_dot2_f32_bf16 v88, v120, s64, v88
    v_dot2_f32_bf16 v89, v121, s64, v89
    v_dot2_f32_bf16 v88, v122, s64, v88
    v_dot2_f32_bf16 v89, v123, s64, v89
    v_dot2_f32_bf16 v28, v236, v236, v28
    v_dot2_f32_bf16 v29, v237, v237, v29
    v_dot2_f32_bf16 v28, v238, v238, v28
    v_dot2_f32_bf16 v29, v239, v239, v29
    v_add_f32 v88, v88, v89
    s_waitcnt lgkmcnt(4)
    v_mfma_f32_32x32x16_bf16 v[48:63], v[100:103], v[224:227], v[48:63]
    v_add_u32 v253, s90, v20
    v_add_f32 v28, v28, v29
    v_mov_b32 v29, v28
    v_dot2_f32_bf16 v90, v100, s64, v90
    v_dot2_f32_bf16 v91, v101, s64, v91
    v_dot2_f32_bf16 v90, v102, s64, v90
    v_dot2_f32_bf16 v91, v103, s64, v91
    v_mov_b32 v30, v44
    v_mov_b32 v31, v44
    v_permlane32_swap_b32 v28, v29
    s_nop 0
    v_permlane32_swap_b32 v30, v31
    v_mul_f32 v92, 0xbb124925, v31
    v_add_f32 v28, v28, v29
    v_mul_f32 v28, 0x3b124925, v28
    v_mfma_f32_32x32x2_f32 v[32:47], v88, v92, v[32:47]
    v_fma_f32 v28, -v92, v92, v28
    v_add_f32 v28, 0x3727c5ac, v28
    v_rsq_f32 v94, v28
    v_dot2_f32_bf16 v90, v108, s64, v90
    v_dot2_f32_bf16 v91, v109, s64, v91
    v_dot2_f32_bf16 v90, v110, s64, v90
    v_dot2_f32_bf16 v91, v111, s64, v91
    v_mfma_f32_32x32x16_bf16 v[48:63], v[108:111], v[228:231], v[48:63]
    v_dot2_f32_bf16 v90, v116, s64, v90
    v_dot2_f32_bf16 v91, v117, s64, v91
    v_dot2_f32_bf16 v90, v118, s64, v90
    v_dot2_f32_bf16 v91, v119, s64, v91
    v_dot2_f32_bf16 v90, v124, s64, v90
    v_dot2_f32_bf16 v91, v125, s64, v91
    v_dot2_f32_bf16 v90, v126, s64, v90
    v_dot2_f32_bf16 v91, v127, s64, v91
    v_mul_f32 v248, 1069066811, v94
    s_nop 1
    v_add_f32 v90, v90, v91
    v_cvt_pk_bf16_f32 v240, v32, v33
    v_cvt_pk_bf16_f32 v241, v34, v35
L_ihka_3:
    s_cbranch_execz L_ihka_ret
    v_cvt_pk_bf16_f32 v242, v36, v37
    v_cvt_pk_bf16_f32 v243, v38, v39
    v_cvt_pk_bf16_f32 v244, v40, v41
    v_cvt_pk_bf16_f32 v245, v42, v43
    v_cvt_pk_bf16_f32 v246, v44, v45
    v_cvt_pk_bf16_f32 v247, v46, v47
    s_waitcnt lgkmcnt(0)
    v_mfma_f32_32x32x16_bf16 v[64:79], v[80:83], v[240:243], 0
    v_mfma_f32_32x32x16_bf16 v[64:79], v[84:87], v[244:247], v[64:79]
    v_bfe_u32 v30, v0, 1, 2
    v_bfe_u32 v31, v0, 4, 2
    v_xor_b32 v30, v30, v31
    v_and_b32 v31, 1, v0
    v_mfma_f32_32x32x16_bf16 v[48:63], v[116:119], v[232:235], v[48:63]
    v_lshl_add_u32 v30, v30, 1, v31
    v_lshrrev_b32 v31, 3, v0
    v_mul_u32_u24 v31, 896, v31
    v_lshl_add_u32 v9, v30, 4, v31
    v_add_u32 v10, 6144, v9
    v_mfma_f32_32x32x16_bf16 v[48:63], v[124:127], v[236:239], v[48:63]
    v_add_u32 v11, 12288, v9
    v_add_u32 v12, 18432, v9
    s_nop 7
    v_mfma_f32_32x32x2_f32 v[48:63], v90, v92, v[48:63]
    s_barrier
    v_max3_f32 v240, v64, v65, v66
    v_max3_f32 v241, -v64, -v65, -v66
    v_max3_f32 v240, v240, v67, v68
    v_max3_f32 v241, v241, -v67, -v68
    v_max3_f32 v240, v240, v69, v70
    v_max3_f32 v241, v241, -v69, -v70
    v_max3_f32 v240, v240, v71, v72
    v_max3_f32 v241, v241, -v71, -v72
    v_max3_f32 v240, v240, v73, v74
    v_max3_f32 v241, v241, -v73, -v74
    v_max3_f32 v240, v240, v75, v76
    v_max3_f32 v241, v241, -v75, -v76
    v_max3_f32 v240, v240, v77, v78
    v_max3_f32 v241, v241, -v77, -v78
    v_max_f32 v240, v240, v79
    v_max_f32_e64 v241, -v79, v241
    s_nop 1
    v_permlane32_swap_b32 v240, v241
    v_max_f32 v240, v240, v241
    v_mul_f32 v240, v240, v248
    v_sub_f32 v240, 0, v240
    v_mov_b32 v242, v240
    v_mov_b32 v244, v240
    s_nop 1
    v_permlane32_swap_b32 v242, v244
    v_add_f32 v246, v242, v24
    v_add_f32 v240, v244, v24
    v_pk_fma_f32 v[32:33], v[64:65], v[248:249], v[242:243] op_sel_hi:[1,0,0]
    v_pk_fma_f32 v[34:35], v[66:67], v[248:249], v[242:243] op_sel_hi:[1,0,0]
    v_pk_fma_f32 v[36:37], v[68:69], v[248:249], v[242:243] op_sel_hi:[1,0,0]
    v_pk_fma_f32 v[38:39], v[70:71], v[248:249], v[242:243] op_sel_hi:[1,0,0]
    v_pk_fma_f32 v[40:41], v[72:73], v[248:249], v[242:243] op_sel_hi:[1,0,0]
    v_pk_fma_f32 v[42:43], v[74:75], v[248:249], v[242:243] op_sel_hi:[1,0,0]
    v_pk_fma_f32 v[44:45], v[76:77], v[248:249], v[246:247] op_sel_hi:[1,0,0]
    v_pk_fma_f32 v[46:47], v[78:79], v[248:249], v[246:247] op_sel_hi:[1,0,0]
    v_pk_fma_f32 v[104:105], v[64:65], v[248:249], v[244:245] op_sel_hi:[1,0,0] neg_lo:[1,0,0] neg_hi:[1,0,0]
    v_pk_fma_f32 v[106:107], v[66:67], v[248:249], v[244:245] op_sel_hi:[1,0,0] neg_lo:[1,0,0] neg_hi:[1,0,0]
    v_pk_fma_f32 v[108:109], v[68:69], v[248:249], v[244:245] op_sel_hi:[1,0,0] neg_lo:[1,0,0] neg_hi:[1,0,0]
    v_pk_fma_f32 v[110:111], v[70:71], v[248:249], v[244:245] op_sel_hi:[1,0,0] neg_lo:[1,0,0] neg_hi:[1,0,0]
    v_pk_fma_f32 v[112:113], v[72:73], v[248:249], v[244:245] op_sel_hi:[1,0,0] neg_lo:[1,0,0] neg_hi:[1,0,0]
    v_pk_fma_f32 v[114:115], v[74:75], v[248:249], v[244:245] op_sel_hi:[1,0,0] neg_lo:[1,0,0] neg_hi:[1,0,0]
    v_pk_fma_f32 v[116:117], v[76:77], v[248:249], v[240:241] op_sel_hi:[1,0,0] neg_lo:[1,0,0] neg_hi:[1,0,0]
    v_pk_fma_f32 v[118:119], v[78:79], v[248:249], v[240:241] op_sel_hi:[1,0,0] neg_lo:[1,0,0] neg_hi:[1,0,0]
    v_mul_f32 v48, v48, v94
    v_mul_f32 v49, v49, v94
    v_mul_f32 v50, v50, v94
    v_mul_f32 v51, v51, v94
    v_mul_f32 v52, v52, v94
    v_mul_f32 v53, v53, v94
    v_mul_f32 v54, v54, v94
    v_mul_f32 v55, v55, v94
    v_mul_f32 v56, v56, v94
    v_mul_f32 v57, v57, v94
    v_mul_f32 v58, v58, v94
    v_mul_f32 v59, v59, v94
    v_mul_f32 v60, v60, v94
    v_mul_f32 v61, v61, v94
    v_mul_f32 v62, v62, v94
    v_mul_f32 v63, v63, v94
    v_cvt_pk_bf16_f32 v96, v48, v49
    v_cvt_pk_bf16_f32 v97, v50, v51
    v_cvt_pk_bf16_f32 v98, v52, v53
    v_cvt_pk_bf16_f32 v99, v54, v55
    v_cvt_pk_bf16_f32 v100, v56, v57
    v_cvt_pk_bf16_f32 v101, v58, v59
    v_cvt_pk_bf16_f32 v102, v60, v61
    v_cvt_pk_bf16_f32 v103, v62, v63
    s_mov_b32 exec_lo, 0
    v_mov_b32 v102, 0x3f80
    v_mov_b32 v103, 0
    s_mov_b32 exec_lo, -1
    ds_write_b64 v21, v[96:97] offset:128
    ds_write_b64 v21, v[98:99] offset:144
    ds_write_b64 v21, v[100:101] offset:160
    ds_write_b64 v21, v[102:103] offset:176
    v_exp_f32 v32, v32
    v_exp_f32 v33, v33
    v_exp_f32 v34, v34
    v_exp_f32 v35, v35
    v_exp_f32 v36, v36
    v_exp_f32 v37, v37
    v_exp_f32 v38, v38
    v_exp_f32 v39, v39
    v_exp_f32 v40, v40
    v_exp_f32 v41, v41
    v_exp_f32 v42, v42
    v_exp_f32 v43, v43
    v_exp_f32 v44, v44
    v_exp_f32 v45, v45
    v_exp_f32 v46, v46
    v_exp_f32 v47, v47
    v_exp_f32 v104, v104
    v_exp_f32 v105, v105
    v_exp_f32 v106, v106
    v_exp_f32 v107, v107
    v_exp_f32 v108, v108
    v_exp_f32 v109, v109
    v_exp_f32 v110, v110
    v_exp_f32 v111, v111
    v_exp_f32 v112, v112
    v_exp_f32 v113, v113
    v_exp_f32 v114, v114
    v_exp_f32 v115, v115
    v_exp_f32 v116, v116
    v_exp_f32 v117, v117
    v_exp_f32 v118, v118
    v_exp_f32 v119, v119
    v_pk_add_f32 v[240:241], v[32:33], v[34:35]
    v_pk_add_f32 v[242:243], v[104:105], v[106:107]
    v_pk_add_f32 v[240:241], v[240:241], v[36:37]
    v_pk_add_f32 v[242:243], v[242:243], v[108:109]
    v_pk_add_f32 v[240:241], v[240:241], v[38:39]
    v_pk_add_f32 v[242:243], v[242:243], v[110:111]
    v_pk_add_f32 v[240:241], v[240:241], v[40:41]
    v_pk_add_f32 v[242:243], v[242:243], v[112:113]
    v_pk_add_f32 v[240:241], v[240:241], v[42:43]
    v_pk_add_f32 v[242:243], v[242:243], v[114:115]
    v_pk_add_f32 v[240:241], v[240:241], v[44:45]
    v_pk_add_f32 v[242:243], v[242:243], v[116:117]
    v_pk_add_f32 v[240:241], v[240:241], v[46:47]
    v_pk_add_f32 v[242:243], v[242:243], v[118:119]
    v_add_f32 v240, v240, v241
    v_add_f32 v242, v242, v243
    s_nop 1
    v_permlane32_swap_b32 v240, v242
    v_add_f32 v240, v240, v242
    v_rcp_f32 v240, v240
    s_nop 0
    v_mov_b32 v242, v240
    s_nop 1
    v_permlane32_swap_b32 v240, v242
    v_pk_mul_f32 v[32:33], v[32:33], v[240:241] op_sel_hi:[1,0]
    v_pk_mul_f32 v[34:35], v[34:35], v[240:241] op_sel_hi:[1,0]
    v_pk_mul_f32 v[36:37], v[36:37], v[240:241] op_sel_hi:[1,0]
    v_pk_mul_f32 v[38:39], v[38:39], v[240:241] op_sel_hi:[1,0]
    v_pk_mul_f32 v[40:41], v[40:41], v[240:241] op_sel_hi:[1,0]
    v_pk_mul_f32 v[42:43], v[42:43], v[240:241] op_sel_hi:[1,0]
    v_pk_mul_f32 v[44:45], v[44:45], v[240:241] op_sel_hi:[1,0]
    v_pk_mul_f32 v[46:47], v[46:47], v[240:241] op_sel_hi:[1,0]
    v_cvt_pk_bf16_f32 v120, v32, v33
    v_cvt_pk_bf16_f32 v121, v34, v35
    v_cvt_pk_bf16_f32 v122, v36, v37
L_ihs0_1:
    s_cbranch_execz L_ihs0_ret
    v_cvt_pk_bf16_f32 v123, v38, v39
    v_cvt_pk_bf16_f32 v124, v40, v41
    v_cvt_pk_bf16_f32 v125, v42, v43
    v_cvt_pk_bf16_f32 v126, v44, v45
    v_cvt_pk_bf16_f32 v127, v46, v47
    v_pk_mul_f32 v[104:105], v[104:105], v[242:243] op_sel_hi:[1,0]
    v_pk_mul_f32 v[106:107], v[106:107], v[242:243] op_sel_hi:[1,0]
    v_pk_mul_f32 v[108:109], v[108:109], v[242:243] op_sel_hi:[1,0]
    v_pk_mul_f32 v[110:111], v[110:111], v[242:243] op_sel_hi:[1,0]
    v_pk_mul_f32 v[112:113], v[112:113], v[242:243] op_sel_hi:[1,0]
    v_pk_mul_f32 v[114:115], v[114:115], v[242:243] op_sel_hi:[1,0]
    v_pk_mul_f32 v[116:117], v[116:117], v[242:243] op_sel_hi:[1,0]
    v_pk_mul_f32 v[118:119], v[118:119], v[242:243] op_sel_hi:[1,0]
    v_cvt_pk_bf16_f32 v64, v104, v105
    v_cvt_pk_bf16_f32 v65, v106, v107
    v_cvt_pk_bf16_f32 v66, v108, v109
    v_cvt_pk_bf16_f32 v67, v110, v111
    v_cvt_pk_bf16_f32 v68, v112, v113
    v_cvt_pk_bf16_f32 v69, v114, v115
    v_cvt_pk_bf16_f32 v70, v116, v117
    v_cvt_pk_bf16_f32 v71, v118, v119
    ds_write_b64 v21, v[120:121] offset:0
    ds_write_b64 v21, v[122:123] offset:16
    ds_write_b64 v21, v[124:125] offset:32
    ds_write_b64 v21, v[126:127] offset:48
    ds_write_b64 v21, v[64:65] offset:64
    ds_write_b64 v21, v[66:67] offset:80
    ds_write_b64 v21, v[68:69] offset:96
    ds_write_b64 v21, v[70:71] offset:112
    s_mov_b64 exec, 268435455
    s_mul_i32 s74, s98, 3584
    s_add_u32 s74, s74, 0
    buffer_load_dword a255, v20, s[24:27], s74 offen
    s_mov_b64 exec, -1
    v_mul_u32_u24 v30, 108, v0
    s_mul_i32 s74, s91, 224
    s_mov_b64 exec, 7
    buffer_load_dword a255, v30, s[28:31], s74 offen
    s_mov_b64 exec, -1
    s_lshl_b32 s74, s71, 7
    s_mov_b64 exec, 1
    buffer_load_dword a255, off, s[36:39], s74
    s_mov_b64 exec, -1
    s_waitcnt vmcnt(12)
    v_cmp_eq_u32 vcc, 0, v251
    s_cbranch_vccnz L_non_1
L_nonok_2:
    v_readfirstlane_b32 s100, v250
    v_readfirstlane_b32 s101, v251
    v_bfe_u32 v16, v250, 0, 8
    v_bfe_u32 v17, v250, 8, 8
    v_bfe_u32 v18, v250, 16, 8
    v_bfe_u32 v25, v250, 24, 8
    s_waitcnt lgkmcnt(0)
    s_barrier
    ds_read_b64_tr_b16 v[32:33], v22 offset:0
    ds_read_b64_tr_b16 v[34:35], v22 offset:3200
    ds_read_b64_tr_b16 v[36:37], v23 offset:0
    ds_read_b64_tr_b16 v[38:39], v23 offset:3200
    ds_read_b64_tr_b16 v[40:41], v23 offset:32
    ds_read_b64_tr_b16 v[42:43], v23 offset:3232
    ds_read_b64_tr_b16 v[44:45], v22 offset:16384
    ds_read_b64_tr_b16 v[46:47], v22 offset:19584
    ds_read_b64_tr_b16 v[48:49], v23 offset:16384
    ds_read_b64_tr_b16 v[50:51], v23 offset:19584
    ds_read_b64_tr_b16 v[52:53], v23 offset:16416
    ds_read_b64_tr_b16 v[54:55], v23 offset:19616
    ds_read_b64_tr_b16 v[56:57], v22 offset:32768
    ds_read_b64_tr_b16 v[58:59], v22 offset:35968
    ds_read_b64_tr_b16 v[60:61], v23 offset:32768
    ds_read_b64_tr_b16 v[62:63], v23 offset:35968
    ds_read_b64_tr_b16 v[64:65], v23 offset:32800
    ds_read_b64_tr_b16 v[66:67], v23 offset:36000
    ds_read_b64_tr_b16 v[68:69], v22 offset:49152
    ds_read_b64_tr_b16 v[70:71], v22 offset:52352
    ds_read_b64_tr_b16 v[72:73], v23 offset:49152
    ds_read_b64_tr_b16 v[74:75], v23 offset:52352
    ds_read_b64_tr_b16 v[76:77], v23 offset:49184
    ds_read_b64_tr_b16 v[78:79], v23 offset:52384
    s_cmp_lg_u32 s3, 0
    s_cbranch_scc1 L_noflag
    s_or_b32 s7, s101, s68
    v_mov_b32 v251, s7
    s_lshl_b32 s61, s4, 4
    s_add_u32 s61, s61, s5
    s_lshl_b32 s61, s61, 3
    s_add_u32 s61, s61, 13631488
    s_mov_b64 exec, 1
    buffer_store_dwordx2 v[250:251], off, s[48:51], s61 sc1
    s_lshl_b32 s61, s5, 4
    s_add_u32 s61, s61, s4
    s_lshl_b32 s61, s61, 3
    s_add_u32 s61, s61, 13635584
    buffer_store_dwordx2 v[250:251], off, s[48:51], s61 sc1
    s_mov_b64 exec, -1
    s_nop 1
L_noflag:
    v_bfe_u32 v30, v0, 4, 1
    v_lshlrev_b32 v30, 9, v30
    v_bfe_u32 v31, v0, 2, 2
    v_lshl_add_u32 v30, v31, 7, v30
    v_lshrrev_b32 v31, 5, v0
    v_lshl_add_u32 v30, v31, 6, v30
    v_and_b32 v31, 3, v0
    v_lshl_add_u32 v30, v31, 4, v30
    s_mov_b32 s7, 0xffffff00
    s_waitcnt lgkmcnt(15)
    v_mfma_f32_16x16x32_bf16 v[96:99], v[32:35], v[36:39], 0
    v_lshrrev_b32 v15, 2, v0
    v_lshlrev_b32 v15, 7, v15
    v_mfma_f32_16x16x32_bf16 v[100:103], v[32:35], v[40:43], 0
    v_and_b32 v14, 3, v0
    v_lshl_add_u32 v15, v14, 3, v15
    s_waitcnt lgkmcnt(12)
    v_mfma_f32_16x16x32_bf16 v[96:99], v[44:47], v[48:51], v[96:99]
    v_bfe_u32 v14, v0, 3, 2
    v_lshl_add_u32 v21, v14, 5, v15
    v_mfma_f32_16x16x32_bf16 v[100:103], v[44:47], v[52:55], v[100:103]
    v_xor_b32 v13, 32, v21
    v_xor_b32 v14, 64, v21
    s_waitcnt lgkmcnt(6)
    v_mfma_f32_16x16x32_bf16 v[96:99], v[56:59], v[60:63], v[96:99]
    v_xor_b32 v15, 96, v21
    v_mfma_f32_16x16x32_bf16 v[100:103], v[56:59], v[64:67], v[100:103]
    s_waitcnt lgkmcnt(0)
    v_mfma_f32_16x16x32_bf16 v[96:99], v[68:71], v[72:75], v[96:99]
    v_mfma_f32_16x16x32_bf16 v[100:103], v[68:71], v[76:79], v[100:103]
    s_nop 6
    v_and_or_b32 v96, v96, s7, v16
    v_and_or_b32 v97, v97, s7, v17
    v_and_or_b32 v98, v98, s7, v18
    v_and_or_b32 v99, v99, s7, v25
    buffer_store_dwordx4 v[96:99], v30, s[48:51], s70 offen sc1
    v_and_or_b32 v100, v100, s7, v16
    v_and_or_b32 v101, v101, s7, v17
    v_and_or_b32 v102, v102, s7, v18
    v_and_or_b32 v103, v103, s7, v25
    buffer_store_dwordx4 v[100:103], v30, s[48:51], s70 offen offset:1024 sc1
    s_waitcnt vmcnt(7)
    s_barrier
    ds_read_b64_tr_b16 v[32:33], v95 offset:0
    ds_read_b64_tr_b16 v[34:35], v95 offset:256
    ds_read_b64_tr_b16 v[36:37], v95 offset:1024
    ds_read_b64_tr_b16 v[38:39], v95 offset:1280
    ds_read_b64_tr_b16 v[40:41], v95 offset:2048
    ds_read_b64_tr_b16 v[42:43], v95 offset:2304
    ds_read_b64_tr_b16 v[44:45], v95 offset:3072
    ds_read_b64_tr_b16 v[46:47], v95 offset:3328
    ds_read_b64_tr_b16 v[48:49], v95 offset:4096
    ds_read_b64_tr_b16 v[50:51], v95 offset:4352
    ds_read_b64_tr_b16 v[52:53], v95 offset:5120
L_ihs0_2:
    s_cbranch_execz L_ihs0_ret
    ds_read_b64_tr_b16 v[54:55], v95 offset:5376
    ds_read_b64_tr_b16 v[56:57], v95 offset:6144
    ds_read_b64_tr_b16 v[58:59], v95 offset:6400
    ds_read_b64_tr_b16 v[104:105], v19 offset:0
    ds_read_b64_tr_b16 v[106:107], v19 offset:256
    ds_read_b64_tr_b16 v[108:109], v19 offset:1024
    ds_read_b64_tr_b16 v[110:111], v19 offset:1280
    ds_read_b64_tr_b16 v[112:113], v19 offset:2048
    ds_read_b64_tr_b16 v[114:115], v19 offset:2304
    ds_read_b64_tr_b16 v[116:117], v19 offset:3072
    ds_read_b64_tr_b16 v[118:119], v19 offset:3328
    v_add_u32 v93, 158720, v1
    s_lshl_b32 s7, s3, 2
    v_add_u32 v31, s7, v93
    s_waitcnt lgkmcnt(15)
    v_dot2_f32_bf16 v28, v32, s64, 0
    v_dot2_f32_bf16 v29, v33, s64, 0
    v_dot2_f32_bf16 v28, v34, s64, v28
    v_dot2_f32_bf16 v29, v35, s64, v29
    v_dot2_f32_bf16 v28, v36, s64, v28
    v_dot2_f32_bf16 v29, v37, s64, v29
    v_dot2_f32_bf16 v28, v38, s64, v28
    v_dot2_f32_bf16 v29, v39, s64, v29
    v_dot2_f32_bf16 v28, v40, s64, v28
    v_dot2_f32_bf16 v29, v41, s64, v29
    v_dot2_f32_bf16 v28, v42, s64, v28
    v_dot2_f32_bf16 v29, v43, s64, v29
    s_waitcnt lgkmcnt(14)
    v_dot2_f32_bf16 v28, v44, s64, v28
    v_dot2_f32_bf16 v29, v45, s64, v29
    v_dot2_f32_bf16 v28, v46, s64, v28
    v_dot2_f32_bf16 v29, v47, s64, v29
    s_waitcnt lgkmcnt(12)
    v_dot2_f32_bf16 v28, v48, s64, v28
    v_dot2_f32_bf16 v29, v49, s64, v29
    v_dot2_f32_bf16 v28, v50, s64, v28
    v_dot2_f32_bf16 v29, v51, s64, v29
    s_waitcnt lgkmcnt(10)
    v_dot2_f32_bf16 v28, v52, s64, v28
    v_dot2_f32_bf16 v29, v53, s64, v29
    v_dot2_f32_bf16 v28, v54, s64, v28
    v_dot2_f32_bf16 v29, v55, s64, v29
    s_waitcnt lgkmcnt(8)
    v_dot2_f32_bf16 v28, v56, s64, v28
    v_dot2_f32_bf16 v29, v57, s64, v29
    v_dot2_f32_bf16 v28, v58, s64, v28
    v_dot2_f32_bf16 v29, v59, s64, v29
    s_nop 2
    v_add_f32 v28, v28, v29
    ds_write_b32 v31, v28
    s_waitcnt lgkmcnt(7)
    v_mfma_f32_32x32x16_bf16 v[64:79], v[104:107], v[128:131], 0
    ds_read_b64_tr_b16 v[120:121], v19 offset:4096
    ds_read_b64_tr_b16 v[122:123], v19 offset:4352
    s_add_u32 m0, s67, 0
    s_add_u32 s92, s75, 0
    buffer_load_dwordx4 v9, s[20:23], s92 offen lds
    v_lshrrev_b32 v5, 3, v0
    s_waitcnt lgkmcnt(7)
    v_mfma_f32_32x32x16_bf16 v[64:79], v[108:111], v[132:135], v[64:79]
    ds_read_b64_tr_b16 v[124:125], v19 offset:5120
    ds_read_b64_tr_b16 v[126:127], v19 offset:5376
    v_lshlrev_b32 v5, 13, v5
    v_and_b32 v31, 7, v0
    v_lshl_add_u32 v5, v31, 4, v5
    s_lshl_b32 s52, s5, 6
    s_waitcnt lgkmcnt(7)
    v_mfma_f32_32x32x16_bf16 v[64:79], v[112:115], v[136:139], v[64:79]
    ds_read_b64_tr_b16 v[104:105], v19 offset:6144
    ds_read_b64_tr_b16 v[106:107], v19 offset:6400
    buffer_load_dwordx4 v10, s[20:23], s92 offen offset:1024 lds
    s_add_u32 s52, s52, s3
    s_lshl_b32 s52, s52, 11
    s_bfe_u32 s7, s4, 0x10002
    s_waitcnt lgkmcnt(7)
    v_mfma_f32_32x32x16_bf16 v[64:79], v[116:119], v[140:143], v[64:79]
    ds_read_b64_tr_b16 v[108:109], v19 offset:7168
    ds_read_b64_tr_b16 v[110:111], v19 offset:7424
    s_lshl_b32 s7, s7, 10
    s_add_u32 s52, s52, s7
    s_lshr_b32 s7, s4, 3
    s_lshl_b32 s7, s7, 9
    s_waitcnt lgkmcnt(6)
    v_mfma_f32_32x32x16_bf16 v[64:79], v[120:123], v[144:147], v[64:79]
    ds_read_b64_tr_b16 v[112:113], v19 offset:8192
    ds_read_b64_tr_b16 v[114:115], v19 offset:8448
    buffer_load_dwordx4 v11, s[20:23], s92 offen offset:2048 lds
    s_add_u32 s52, s52, s7
    s_and_b32 s7, s4, 3
    s_lshl_b32 s7, s7, 7
    s_waitcnt lgkmcnt(6)
    v_mfma_f32_32x32x16_bf16 v[64:79], v[124:127], v[148:151], v[64:79]
    ds_read_b64_tr_b16 v[116:117], v19 offset:9216
    ds_read_b64_tr_b16 v[118:119], v19 offset:9472
    s_add_u32 s52, s52, s7
    s_add_u32 s53, s52, 0x10000
    v_mul_u32_u24 v30, 37, v0
    v_lshrrev_b32 v30, 9, v30
    s_waitcnt lgkmcnt(6)
    v_mfma_f32_32x32x16_bf16 v[64:79], v[104:107], v[152:155], v[64:79]
    ds_read_b64_tr_b16 v[120:121], v19 offset:10240
    ds_read_b64_tr_b16 v[122:123], v19 offset:10496
    buffer_load_dwordx4 v12, s[20:23], s92 offen offset:3072 lds
    v_mul_u32_u24 v31, 14, v30
    v_sub_u32 v31, v0, v31
    s_movk_i32 s7, 3584
    s_waitcnt lgkmcnt(6)
    v_mfma_f32_32x32x16_bf16 v[64:79], v[108:111], v[156:159], v[64:79]
    ds_read_b64_tr_b16 v[124:125], v19 offset:11264
    ds_read_b64_tr_b16 v[126:127], v19 offset:11520
    v_mul_u32_u24 v30, s7, v30
    v_lshl_add_u32 v16, v31, 4, v30
    v_add_u32 v17, 13440, v16
    v_add_u32 v18, 26880, v16
    s_waitcnt lgkmcnt(6)
    v_mfma_f32_32x32x16_bf16 v[64:79], v[112:115], v[160:163], v[64:79]
    ds_read_b64_tr_b16 v[104:105], v19 offset:12288
    ds_read_b64_tr_b16 v[106:107], v19 offset:12544
    s_add_u32 m0, s67, 4096
    s_add_u32 s92, s75, 28672
    buffer_load_dwordx4 v9, s[20:23], s92 offen lds
    v_add_u32 v25, 40320, v16
    s_waitcnt lgkmcnt(6)
    v_mfma_f32_32x32x16_bf16 v[64:79], v[116:119], v[164:167], v[64:79]
    ds_read_b64_tr_b16 v[108:109], v19 offset:13312
    ds_read_b64_tr_b16 v[110:111], v19 offset:13568
    s_mul_i32 s97, s3, 57344
    s_mul_i32 s7, s91, 224
    s_add_u32 s97, s97, s7
    s_mov_b32 s61, 0x0c0c0400
    s_waitcnt lgkmcnt(6)
    v_mfma_f32_32x32x16_bf16 v[64:79], v[120:123], v[168:171], v[64:79]
    ds_read_b64_tr_b16 v[112:113], v19 offset:14336
    ds_read_b64_tr_b16 v[114:115], v19 offset:14592
    buffer_load_dwordx4 v10, s[20:23], s92 offen offset:1024 lds
    s_mov_b32 s62, 0x04000c0c
    v_and_b32 v6, 3, v0
    v_lshlrev_b32 v6, 4, v6
    s_waitcnt lgkmcnt(6)
    v_mfma_f32_32x32x16_bf16 v[64:79], v[124:127], v[172:175], v[64:79]
    ds_read_b64_tr_b16 v[116:117], v19 offset:15360
    ds_read_b64_tr_b16 v[118:119], v19 offset:15616
    v_bfe_u32 v31, v0, 2, 1
    v_lshl_add_u32 v6, v31, 3, v6
    v_lshrrev_b32 v31, 5, v0
    v_lshl_add_u32 v6, v31, 2, v6
    s_waitcnt lgkmcnt(6)
    v_mfma_f32_32x32x16_bf16 v[64:79], v[104:107], v[176:179], v[64:79]
    ds_read_b64_tr_b16 v[120:121], v19 offset:16384
    ds_read_b64_tr_b16 v[122:123], v19 offset:16640
    buffer_load_dwordx4 v11, s[20:23], s92 offen offset:2048 lds
    v_lshrrev_b32 v30, 5, v0
    s_mul_i32 s7, s5, 7
    v_add_u32 v30, s7, v30
    s_waitcnt lgkmcnt(6)
    v_mfma_f32_32x32x16_bf16 v[64:79], v[108:111], v[180:183], v[64:79]
    ds_read_b64_tr_b16 v[124:125], v19 offset:17408
    ds_read_b64_tr_b16 v[126:127], v19 offset:17664
    v_and_b32 v31, 15, v0
    v_lshlrev_b32 v31, 4, v31
    v_bfe_u32 v89, v0, 4, 1
    s_movk_i32 s7, 14336
    s_waitcnt lgkmcnt(6)
    v_mfma_f32_32x32x16_bf16 v[64:79], v[112:115], v[184:187], v[64:79]
    ds_read_b64_tr_b16 v[104:105], v19 offset:18432
    ds_read_b64_tr_b16 v[106:107], v19 offset:18688
    buffer_load_dwordx4 v12, s[20:23], s92 offen offset:3072 lds
    v_mad_u32_u24 v31, v89, s7, v31
    v_add_u32 v89, 0, v30
    v_lshrrev_b32 v7, 3, v89
    s_waitcnt lgkmcnt(6)
    v_mfma_f32_32x32x16_bf16 v[64:79], v[116:119], v[188:191], v[64:79]
    ds_read_b64_tr_b16 v[108:109], v19 offset:19456
    ds_read_b64_tr_b16 v[110:111], v19 offset:19712
    v_lshl_add_u32 v7, v7, 10, v31
    v_and_b32 v90, 3, v89
    v_lshl_add_u32 v7, v90, 8, v7
    v_bfe_u32 v90, v89, 2, 1
    s_waitcnt lgkmcnt(6)
    v_mfma_f32_32x32x16_bf16 v[64:79], v[120:123], v[192:195], v[64:79]
    ds_read_b64_tr_b16 v[112:113], v19 offset:20480
    ds_read_b64_tr_b16 v[114:115], v19 offset:20736
    s_add_u32 m0, s67, 8192
    s_add_u32 s92, s75, 57344
    buffer_load_dwordx4 v9, s[20:23], s92 offen lds
    v_lshl_add_u32 v7, v90, 3, v7
    s_waitcnt lgkmcnt(6)
    v_mfma_f32_32x32x16_bf16 v[64:79], v[124:127], v[196:199], v[64:79]
    ds_read_b64_tr_b16 v[116:117], v19 offset:21504
    ds_read_b64_tr_b16 v[118:119], v19 offset:21760
    v_add_u32 v89, 2, v30
    v_lshrrev_b32 v8, 3, v89
    v_lshl_add_u32 v8, v8, 10, v31
    v_and_b32 v90, 3, v89
    s_waitcnt lgkmcnt(6)
    v_mfma_f32_32x32x16_bf16 v[64:79], v[104:107], v[200:203], v[64:79]
    ds_read_b64_tr_b16 v[120:121], v19 offset:22528
    ds_read_b64_tr_b16 v[122:123], v19 offset:22784
    buffer_load_dwordx4 v10, s[20:23], s92 offen offset:1024 lds
    v_lshl_add_u32 v8, v90, 8, v8
    v_bfe_u32 v90, v89, 2, 1
    v_lshl_add_u32 v8, v90, 3, v8
    s_waitcnt lgkmcnt(6)
    v_mfma_f32_32x32x16_bf16 v[64:79], v[108:111], v[204:207], v[64:79]
    ds_read_b64_tr_b16 v[124:125], v19 offset:23552
    ds_read_b64_tr_b16 v[126:127], v19 offset:23808
    v_add_u32 v89, 4, v30
    v_lshrrev_b32 v26, 3, v89
    v_lshl_add_u32 v26, v26, 10, v31
    v_and_b32 v90, 3, v89
    s_waitcnt lgkmcnt(6)
    v_mfma_f32_32x32x16_bf16 v[64:79], v[112:115], v[208:211], v[64:79]
    ds_read_b64_tr_b16 v[104:105], v19 offset:24576
    ds_read_b64_tr_b16 v[106:107], v19 offset:24832
    buffer_load_dwordx4 v11, s[20:23], s92 offen offset:2048 lds
    v_lshl_add_u32 v26, v90, 8, v26
    v_bfe_u32 v90, v89, 2, 1
    v_lshl_add_u32 v26, v90, 3, v26
    s_waitcnt lgkmcnt(6)
    v_mfma_f32_32x32x16_bf16 v[64:79], v[116:119], v[212:215], v[64:79]
    ds_read_b64_tr_b16 v[108:109], v19 offset:25600
    ds_read_b64_tr_b16 v[110:111], v19 offset:25856
    v_add_u32 v89, 6, v30
    v_lshrrev_b32 v27, 3, v89
    v_lshl_add_u32 v27, v27, 10, v31
    v_and_b32 v90, 3, v89
    s_waitcnt lgkmcnt(6)
    v_mfma_f32_32x32x16_bf16 v[64:79], v[120:123], v[216:219], v[64:79]
    ds_read_b64_tr_b16 v[112:113], v19 offset:26624
    ds_read_b64_tr_b16 v[114:115], v19 offset:26880
    buffer_load_dwordx4 v12, s[20:23], s92 offen offset:3072 lds
    v_lshl_add_u32 v27, v90, 8, v27
    v_bfe_u32 v90, v89, 2, 1
    v_lshl_add_u32 v27, v90, 3, v27
    s_waitcnt lgkmcnt(6)
    v_mfma_f32_32x32x16_bf16 v[64:79], v[124:127], v[220:223], v[64:79]
    ds_read_b64_tr_b16 v[116:117], v19 offset:27648
    ds_read_b64_tr_b16 v[118:119], v19 offset:27904
    s_waitcnt lgkmcnt(6)
    v_mfma_f32_32x32x16_bf16 v[64:79], v[104:107], v[224:227], v[64:79]
    s_add_u32 m0, s67, 12288
    s_add_u32 s92, s75, 86016
    buffer_load_dwordx4 v9, s[20:23], s92 offen lds
    s_waitcnt lgkmcnt(4)
    v_mfma_f32_32x32x16_bf16 v[64:79], v[108:111], v[228:231], v[64:79]
    s_waitcnt lgkmcnt(2)
    v_mfma_f32_32x32x16_bf16 v[64:79], v[112:115], v[232:235], v[64:79]
    buffer_load_dwordx4 v10, s[20:23], s92 offen offset:1024 lds
    s_waitcnt lgkmcnt(0)
    v_mfma_f32_32x32x16_bf16 v[64:79], v[116:119], v[236:239], v[64:79]
    s_waitcnt lgkmcnt(0)
    s_barrier
    ds_read_b128 v[240:243], v93
    v_add_u32 v9, 13312, v2
    v_add_u32 v10, 5120, v2
    v_add_u32 v11, 18432, v2
    v_and_b32 v31, 15, v0
    v_mul_u32_u24 v31, 896, v31
    v_lshrrev_b32 v88, 4, v0
    v_lshl_add_u32 v88, v88, 3, v31
    s_lshl_b32 s72, s4, 1
    s_add_u32 s72, s72, s6
    s_lshl_b32 s72, s72, 2
    s_add_u32 s72, s72, s3
    s_mul_i32 s72, s72, 14336
    s_lshl_b32 s7, s71, 7
    s_add_u32 s72, s72, s7
    buffer_load_dwordx2 v[232:233], v88, s[8:11], s72 offen
    buffer_load_dwordx2 v[234:235], v88, s[8:11], s72 offen offset:32
    buffer_load_dwordx2 v[236:237], v88, s[8:11], s72 offen offset:64
    buffer_load_dwordx2 v[238:239], v88, s[8:11], s72 offen offset:96
    s_and_b32 s73, s91, 1
    v_lshrrev_b32 v30, 3, v0
    v_add_u32 v30, s73, v30
    v_cmp_eq_u32 vcc, 7, v30
    s_waitcnt lgkmcnt(0)
    v_add_f32 v240, v240, v241
    v_add_f32 v242, v242, v243
    v_add_f32 v240, v240, v242
    s_nop 1
    v_mfma_f32_32x32x2_f32 v[64:79], v240, v92, v[64:79]
    v_and_b32 v31, 7, v0
    v_lshlrev_b32 v31, 2, v31
    v_cndmask_b32 v30, v30, 0, vcc
    v_lshl_add_u32 v30, v30, 5, v31
    s_mul_i32 s72, s91, 224
    buffer_load_dword v91, v30, s[28:31], s72 offen
    s_nop 11
    v_cvt_pk_bf16_f32 v96, v64, v65
    v_cvt_pk_bf16_f32 v97, v66, v67
    v_cvt_pk_bf16_f32 v98, v68, v69
    v_cvt_pk_bf16_f32 v99, v70, v71
    v_cvt_pk_bf16_f32 v100, v72, v73
    v_cvt_pk_bf16_f32 v101, v74, v75
    v_cvt_pk_bf16_f32 v102, v76, v77
    v_cvt_pk_bf16_f32 v103, v78, v79
    v_mfma_f32_32x32x16_bf16 v[112:127], v[80:83], v[96:99], 0
    s_nop 0
    v_mfma_f32_32x32x16_bf16 v[112:127], v[84:87], v[100:103], v[112:127]
    buffer_load_dwordx4 v[128:131], v5, s[48:51], s52 offen sc1
    buffer_load_dwordx4 v[132:135], v5, s[48:51], s53 offen sc1
    buffer_load_dwordx2 v[250:251], v249, s[48:51], 0 offen sc1
    s_mov_b64 exec, 268435455
    s_mul_i32 s74, s98, 3584
    s_add_u32 s74, s74, 458752
    buffer_load_dword a255, v20, s[24:27], s74 offen
    s_mov_b64 exec, -1
    s_nop 3
L_ihs0_3:
    s_cbranch_execz L_ihs0_ret
    v_max3_f32 v240, v112, v113, v114
    v_max3_f32 v241, -v112, -v113, -v114
    v_max3_f32 v240, v240, v115, v116
    v_max3_f32 v241, v241, -v115, -v116
    v_max3_f32 v240, v240, v117, v118
    v_max3_f32 v241, v241, -v117, -v118
    v_max3_f32 v240, v240, v119, v120
    v_max3_f32 v241, v241, -v119, -v120
    v_max3_f32 v240, v240, v121, v122
    v_max3_f32 v241, v241, -v121, -v122
    v_max3_f32 v240, v240, v123, v124
    v_max3_f32 v241, v241, -v123, -v124
    v_max3_f32 v240, v240, v125, v126
    v_max3_f32 v241, v241, -v125, -v126
    v_max_f32 v240, v240, v127
    v_max_f32_e64 v241, -v127, v241
    s_nop 1
    v_permlane32_swap_b32 v240, v241
    v_max_f32 v240, v240, v241
    v_mul_f32 v240, v240, v248
    v_sub_f32 v240, 0, v240
    v_mov_b32 v242, v240
    v_mov_b32 v244, v240
    s_nop 1
    v_permlane32_swap_b32 v242, v244
    v_add_f32 v246, v242, v24
    v_add_f32 v240, v244, v24
    v_pk_fma_f32 v[32:33], v[112:113], v[248:249], v[242:243] op_sel_hi:[1,0,0]
    v_pk_fma_f32 v[34:35], v[114:115], v[248:249], v[242:243] op_sel_hi:[1,0,0]
    v_pk_fma_f32 v[36:37], v[116:117], v[248:249], v[242:243] op_sel_hi:[1,0,0]
    v_pk_fma_f32 v[38:39], v[118:119], v[248:249], v[242:243] op_sel_hi:[1,0,0]
    v_pk_fma_f32 v[40:41], v[120:121], v[248:249], v[242:243] op_sel_hi:[1,0,0]
    v_pk_fma_f32 v[42:43], v[122:123], v[248:249], v[242:243] op_sel_hi:[1,0,0]
    v_pk_fma_f32 v[44:45], v[124:125], v[248:249], v[246:247] op_sel_hi:[1,0,0]
    v_pk_fma_f32 v[46:47], v[126:127], v[248:249], v[246:247] op_sel_hi:[1,0,0]
    v_pk_fma_f32 v[48:49], v[112:113], v[248:249], v[244:245] op_sel_hi:[1,0,0] neg_lo:[1,0,0] neg_hi:[1,0,0]
    v_pk_fma_f32 v[50:51], v[114:115], v[248:249], v[244:245] op_sel_hi:[1,0,0] neg_lo:[1,0,0] neg_hi:[1,0,0]
    v_pk_fma_f32 v[52:53], v[116:117], v[248:249], v[244:245] op_sel_hi:[1,0,0] neg_lo:[1,0,0] neg_hi:[1,0,0]
    v_pk_fma_f32 v[54:55], v[118:119], v[248:249], v[244:245] op_sel_hi:[1,0,0] neg_lo:[1,0,0] neg_hi:[1,0,0]
    v_pk_fma_f32 v[56:57], v[120:121], v[248:249], v[244:245] op_sel_hi:[1,0,0] neg_lo:[1,0,0] neg_hi:[1,0,0]
    v_pk_fma_f32 v[58:59], v[122:123], v[248:249], v[244:245] op_sel_hi:[1,0,0] neg_lo:[1,0,0] neg_hi:[1,0,0]
    v_pk_fma_f32 v[60:61], v[124:125], v[248:249], v[240:241] op_sel_hi:[1,0,0] neg_lo:[1,0,0] neg_hi:[1,0,0]
    v_pk_fma_f32 v[62:63], v[126:127], v[248:249], v[240:241] op_sel_hi:[1,0,0] neg_lo:[1,0,0] neg_hi:[1,0,0]
    s_waitcnt vmcnt(2)
    v_perm_b32 v136, v129, v128, s61
    v_perm_b32 v137, v131, v130, s62
    v_perm_b32 v138, v133, v132, s61
    v_perm_b32 v139, v135, v134, s62
    v_or_b32 v136, v136, v137
    v_or_b32 v138, v138, v139
    v_xor_b32 v136, s100, v136
    v_xor_b32 v138, s100, v138
    v_or_b32 v136, v136, v138
    v_cmp_ne_u32 vcc, 0, v136
    s_cbranch_vccnz L_kx_3
L_kxok_4:
    v_add_f32 v128, v128, v132
    v_add_f32 v129, v129, v133
    v_add_f32 v130, v130, v134
    v_add_f32 v131, v131, v135
    v_add_f32_dpp v128, v128, v128 row_ror:8 row_mask:0xf bank_mask:0xf
    v_add_f32_dpp v129, v129, v129 row_ror:8 row_mask:0xf bank_mask:0xf
    v_add_f32_dpp v130, v130, v130 row_ror:8 row_mask:0xf bank_mask:0xf
    v_add_f32_dpp v131, v131, v131 row_ror:8 row_mask:0xf bank_mask:0xf
    v_permlane16_swap_b32 v128, v129
    s_nop 0
    v_permlane16_swap_b32 v130, v131
    v_add_f32 v128, v128, v129
    v_add_f32 v130, v130, v131
    s_nop 1
    v_permlane32_swap_b32 v128, v130
    v_add_f32 v128, v128, v130
    v_mov_b32 v129, v128
    s_nop 1
    v_permlane16_swap_b32 v128, v129
    v_cvt_pk_bf16_f32 v128, v128, v129
    s_mov_b32 exec_lo, 0xff
    s_mov_b32 exec_hi, 0xff
    buffer_store_dword v128, v6, s[48:51], s54 offen sc1
    s_mov_b64 exec, -1
    v_lshlrev_b32 v140, 16, v91
    v_and_b32 v141, 0xffff0000, v91
    v_lshlrev_b32 v30, 3, v0
    v_add_u32 v30, 163264, v30
    s_mov_b32 exec_hi, 0x00ffffff
    ds_write_b64 v30, v[140:141]
    s_mov_b32 exec_hi, -1
    s_barrier
    v_exp_f32 v32, v32
    ds_read_b64_tr_b16 a[112:113], v21 offset:0
    s_lshr_b32 s92, s67, 2
    s_add_u32 m0, s92, 58368
    s_add_u32 s92, s97, 0
    s_mov_b32 exec_hi, 0x00ffffff
    buffer_load_dwordx4 v16, s[24:27], s92 offen lds
    buffer_load_dwordx4 v17, s[24:27], s92 offen offset:896 lds
    buffer_load_dwordx4 v18, s[24:27], s92 offen offset:1792 lds
    buffer_load_dwordx4 v25, s[24:27], s92 offen offset:2688 lds
    s_mov_b32 exec_hi, -1
    v_exp_f32 v33, v33
    ds_read_b64_tr_b16 a[114:115], v21 offset:2048
    v_exp_f32 v34, v34
    ds_read_b64_tr_b16 a[116:117], v13 offset:0
    v_exp_f32 v35, v35
    ds_read_b64_tr_b16 a[118:119], v13 offset:2048
    v_exp_f32 v36, v36
    ds_read_b64_tr_b16 a[120:121], v14 offset:0
    v_exp_f32 v37, v37
    ds_read_b64_tr_b16 a[122:123], v14 offset:2048
    v_exp_f32 v38, v38
    ds_read_b64_tr_b16 a[124:125], v15 offset:0
    v_exp_f32 v39, v39
    ds_read_b64_tr_b16 a[126:127], v15 offset:2048
    v_exp_f32 v40, v40
    ds_read_b64_tr_b16 a[128:129], v21 offset:4096
    v_exp_f32 v41, v41
    ds_read_b64_tr_b16 a[130:131], v21 offset:6144
    v_exp_f32 v42, v42
    ds_read_b64_tr_b16 a[132:133], v13 offset:4096
    v_exp_f32 v43, v43
    ds_read_b64_tr_b16 a[134:135], v13 offset:6144
    v_exp_f32 v44, v44
    ds_read_b64_tr_b16 a[136:137], v14 offset:4096
    v_exp_f32 v45, v45
    ds_read_b64_tr_b16 a[138:139], v14 offset:6144
    v_exp_f32 v46, v46
    ds_read_b64_tr_b16 a[140:141], v15 offset:4096
    v_exp_f32 v47, v47
    ds_read_b64_tr_b16 a[142:143], v15 offset:6144
    v_exp_f32 v48, v48
    ds_read_b64_tr_b16 a[144:145], v21 offset:8192
    v_exp_f32 v49, v49
    ds_read_b64_tr_b16 a[146:147], v21 offset:10240
    v_exp_f32 v50, v50
    ds_read_b64_tr_b16 a[148:149], v13 offset:8192
    v_exp_f32 v51, v51
    ds_read_b64_tr_b16 a[150:151], v13 offset:10240
    v_exp_f32 v52, v52
    ds_read_b64_tr_b16 a[152:153], v14 offset:8192
    v_exp_f32 v53, v53
    ds_read_b64_tr_b16 a[154:155], v14 offset:10240
    v_exp_f32 v54, v54
    ds_read_b64_tr_b16 a[156:157], v15 offset:8192
    v_exp_f32 v55, v55
    ds_read_b64_tr_b16 a[158:159], v15 offset:10240
    v_exp_f32 v56, v56
    ds_read_b64_tr_b16 a[160:161], v21 offset:12288
    v_exp_f32 v57, v57
    ds_read_b64_tr_b16 a[162:163], v21 offset:14336
    v_exp_f32 v58, v58
    ds_read_b64_tr_b16 a[164:165], v13 offset:12288
    v_exp_f32 v59, v59
    ds_read_b64_tr_b16 a[166:167], v13 offset:14336
    v_exp_f32 v60, v60
    ds_read_b64_tr_b16 a[168:169], v14 offset:12288
    s_lshr_b32 s92, s67, 2
    s_add_u32 m0, s92, 72704
    s_add_u32 s92, s97, 229376
    s_mov_b32 exec_hi, 0x00ffffff
    buffer_load_dwordx4 v16, s[24:27], s92 offen lds
    buffer_load_dwordx4 v17, s[24:27], s92 offen offset:896 lds
    buffer_load_dwordx4 v18, s[24:27], s92 offen offset:1792 lds
    buffer_load_dwordx4 v25, s[24:27], s92 offen offset:2688 lds
    s_mov_b32 exec_hi, -1
    v_exp_f32 v61, v61
    ds_read_b64_tr_b16 a[170:171], v14 offset:14336
    v_exp_f32 v62, v62
    ds_read_b64_tr_b16 a[172:173], v15 offset:12288
    v_exp_f32 v63, v63
    ds_read_b64_tr_b16 a[174:175], v15 offset:14336
    v_pk_add_f32 v[240:241], v[32:33], v[34:35]
    v_pk_add_f32 v[242:243], v[48:49], v[50:51]
    v_pk_add_f32 v[240:241], v[240:241], v[36:37]
    v_pk_add_f32 v[242:243], v[242:243], v[52:53]
    ds_read_b64_tr_b16 a[176:177], v21 offset:16384
    v_pk_add_f32 v[240:241], v[240:241], v[38:39]
    v_pk_add_f32 v[242:243], v[242:243], v[54:55]
    v_pk_add_f32 v[240:241], v[240:241], v[40:41]
    v_pk_add_f32 v[242:243], v[242:243], v[56:57]
    ds_read_b64_tr_b16 a[178:179], v21 offset:18432
    v_pk_add_f32 v[240:241], v[240:241], v[42:43]
    v_pk_add_f32 v[242:243], v[242:243], v[58:59]
    v_pk_add_f32 v[240:241], v[240:241], v[44:45]
    v_pk_add_f32 v[242:243], v[242:243], v[60:61]
    ds_read_b64_tr_b16 a[180:181], v13 offset:16384
    v_pk_add_f32 v[240:241], v[240:241], v[46:47]
    v_pk_add_f32 v[242:243], v[242:243], v[62:63]
    v_add_f32 v240, v240, v241
    v_add_f32 v242, v242, v243
    ds_read_b64_tr_b16 a[182:183], v13 offset:18432
    s_nop 0
    v_permlane32_swap_b32 v240, v242
    v_add_f32 v240, v240, v242
    v_rcp_f32 v240, v240
    ds_read_b64_tr_b16 a[184:185], v14 offset:16384
    v_mov_b32 v242, v240
    s_nop 1
    v_permlane32_swap_b32 v240, v242
    v_pk_mul_f32 v[32:33], v[32:33], v[240:241] op_sel_hi:[1,0]
    v_pk_mul_f32 v[34:35], v[34:35], v[240:241] op_sel_hi:[1,0]
    ds_read_b64_tr_b16 a[186:187], v14 offset:18432
    v_pk_mul_f32 v[36:37], v[36:37], v[240:241] op_sel_hi:[1,0]
    v_pk_mul_f32 v[38:39], v[38:39], v[240:241] op_sel_hi:[1,0]
    v_pk_mul_f32 v[40:41], v[40:41], v[240:241] op_sel_hi:[1,0]
    v_pk_mul_f32 v[42:43], v[42:43], v[240:241] op_sel_hi:[1,0]
    ds_read_b64_tr_b16 a[188:189], v15 offset:16384
    v_pk_mul_f32 v[44:45], v[44:45], v[240:241] op_sel_hi:[1,0]
    v_pk_mul_f32 v[46:47], v[46:47], v[240:241] op_sel_hi:[1,0]
    v_cvt_pk_bf16_f32 v64, v32, v33
    v_cvt_pk_bf16_f32 v65, v34, v35
    ds_read_b64_tr_b16 a[190:191], v15 offset:18432
    v_cvt_pk_bf16_f32 v66, v36, v37
    v_cvt_pk_bf16_f32 v67, v38, v39
    v_cvt_pk_bf16_f32 v68, v40, v41
    v_cvt_pk_bf16_f32 v69, v42, v43
    ds_read_b64_tr_b16 a[192:193], v21 offset:20480
    v_cvt_pk_bf16_f32 v70, v44, v45
    v_cvt_pk_bf16_f32 v71, v46, v47
    v_pk_mul_f32 v[48:49], v[48:49], v[242:243] op_sel_hi:[1,0]
    v_pk_mul_f32 v[50:51], v[50:51], v[242:243] op_sel_hi:[1,0]
    ds_read_b64_tr_b16 a[194:195], v21 offset:22528
    v_pk_mul_f32 v[52:53], v[52:53], v[242:243] op_sel_hi:[1,0]
    v_pk_mul_f32 v[54:55], v[54:55], v[242:243] op_sel_hi:[1,0]
    v_pk_mul_f32 v[56:57], v[56:57], v[242:243] op_sel_hi:[1,0]
    v_pk_mul_f32 v[58:59], v[58:59], v[242:243] op_sel_hi:[1,0]
    ds_read_b64_tr_b16 a[196:197], v13 offset:20480
    v_pk_mul_f32 v[60:61], v[60:61], v[242:243] op_sel_hi:[1,0]
    v_pk_mul_f32 v[62:63], v[62:63], v[242:243] op_sel_hi:[1,0]
    v_cvt_pk_bf16_f32 v72, v48, v49
    v_cvt_pk_bf16_f32 v73, v50, v51
    ds_read_b64_tr_b16 a[198:199], v13 offset:22528
    v_cvt_pk_bf16_f32 v74, v52, v53
    v_cvt_pk_bf16_f32 v75, v54, v55
    s_lshr_b32 s92, s67, 2
    s_add_u32 m0, s92, 87040
    s_add_u32 s92, s97, 458752
    s_mov_b32 exec_hi, 0x00ffffff
    buffer_load_dwordx4 v16, s[24:27], s92 offen lds
    buffer_load_dwordx4 v17, s[24:27], s92 offen offset:896 lds
    buffer_load_dwordx4 v18, s[24:27], s92 offen offset:1792 lds
    buffer_load_dwordx4 v25, s[24:27], s92 offen offset:2688 lds
    s_mov_b32 exec_hi, -1
    v_cvt_pk_bf16_f32 v76, v56, v57
    v_cvt_pk_bf16_f32 v77, v58, v59
    ds_read_b64_tr_b16 a[200:201], v14 offset:20480
    v_cvt_pk_bf16_f32 v78, v60, v61
    v_cvt_pk_bf16_f32 v79, v62, v63
    s_waitcnt vmcnt(14)
    v_and_b32 v30, -16, v251
    v_xor_b32 v30, s101, v30
    v_xor_b32 v31, s100, v250
    v_or_b32 v30, v30, v31
    v_cmp_ne_u32 vcc, 0, v30
    s_and_b32 vcc_lo, vcc_lo, -1
    s_mov_b32 vcc_hi, 0
    s_cbranch_vccnz L_rdy_5
L_rdyok_6:
    s_lshl_b32 s53, s5, 12
    s_add_u32 s53, s53, 13697024
    s_lshl_b32 s7, s3, 10
    s_add_u32 m0, s7, 158720
    s_add_u32 s7, s7, s53
    buffer_load_dwordx4 v1, s[48:51], s7 offen sc1 lds
    s_mov_b64 exec, 268435455
    s_mul_i32 s74, s98, 3584
    s_add_u32 s74, s74, 917504
    buffer_load_dword a255, v20, s[24:27], s74 offen
    s_mov_b64 exec, -1
    s_mov_b64 exec, 16383
    s_mul_i32 s74, s98, 1792
    s_add_u32 s74, s74, 1376256
    buffer_load_dword a255, v20, s[24:27], s74 offen
    s_mov_b64 exec, -1
    s_mov_b64 exec, 16383
    s_bitcmp1_b32 s98, 6
    s_cselect_b32 s74, 1, 0
    s_mul_i32 s74, s74, 28672
    s_add_u32 s74, s74, s95
    buffer_load_dword a255, v20, s[32:35], s74 offen
    s_mov_b64 exec, -1
    v_and_b32 v30, 15, v251
    v_cmp_eq_u32 vcc, s68, v30
    s_and_b32 s7, vcc_lo, 0xffff
    s_cmp_eq_u32 s7, 0xffff
    s_cselect_b32 s65, 1, 0
    s_cmp_eq_u32 s65, 0
    s_cbranch_scc1 L_split
L_splitb:
    ds_read_b64_tr_b16 a[202:203], v14 offset:22528
    ds_read_b64_tr_b16 a[204:205], v15 offset:20480
    ds_read_b64_tr_b16 a[206:207], v15 offset:22528
    ds_read_b64_tr_b16 a[208:209], v21 offset:24576
    ds_read_b64_tr_b16 a[210:211], v21 offset:26624
    ds_read_b64_tr_b16 a[212:213], v13 offset:24576
    ds_read_b64_tr_b16 a[214:215], v13 offset:26624
    ds_read_b64_tr_b16 a[216:217], v14 offset:24576
    s_lshr_b32 s92, s67, 2
    s_add_u32 m0, s92, 101376
    s_add_u32 s92, s97, 688128
    s_mov_b32 exec_hi, 0x00ffffff
    buffer_load_dwordx4 v16, s[24:27], s92 offen lds
    buffer_load_dwordx4 v17, s[24:27], s92 offen offset:896 lds
    buffer_load_dwordx4 v18, s[24:27], s92 offen offset:1792 lds
    buffer_load_dwordx4 v25, s[24:27], s92 offen offset:2688 lds
    s_mov_b32 exec_hi, -1
    ds_read_b64_tr_b16 a[218:219], v14 offset:26624
    ds_read_b64_tr_b16 a[220:221], v15 offset:24576
    ds_read_b64_tr_b16 a[222:223], v15 offset:26624
    ds_read_b64_tr_b16 a[224:225], v21 offset:28672
    ds_read_b64_tr_b16 a[226:227], v21 offset:30720
    ds_read_b64_tr_b16 a[228:229], v13 offset:28672
    ds_read_b64_tr_b16 a[230:231], v13 offset:30720
    ds_read_b64_tr_b16 a[232:233], v14 offset:28672
    ds_read_b64_tr_b16 a[234:235], v14 offset:30720
    ds_read_b64_tr_b16 a[236:237], v15 offset:28672
    ds_read_b64_tr_b16 a[238:239], v15 offset:30720
    ds_read_b64_tr_b16 a[240:241], v21 offset:32768
    ds_read_b64_tr_b16 a[242:243], v21 offset:34816
    ds_read_b64_tr_b16 a[244:245], v13 offset:32768
    ds_read_b64_tr_b16 a[246:247], v13 offset:34816
    ds_read_b64_tr_b16 a[248:249], v14 offset:32768
    ds_read_b64_tr_b16 a[250:251], v14 offset:34816
    ds_read_b64_tr_b16 v[160:161], v15 offset:32768
    ds_read_b64_tr_b16 v[162:163], v15 offset:34816
    ds_read_b64_tr_b16 v[164:165], v21 offset:36864
    ds_read_b64_tr_b16 v[166:167], v21 offset:38912
    ds_read_b64_tr_b16 v[168:169], v13 offset:36864
    ds_read_b64_tr_b16 v[170:171], v13 offset:38912
    ds_read_b64_tr_b16 v[172:173], v14 offset:36864
    ds_read_b64_tr_b16 v[174:175], v14 offset:38912
    ds_read_b64_tr_b16 v[176:177], v15 offset:36864
    ds_read_b64_tr_b16 v[178:179], v15 offset:38912
    ds_read_b64_tr_b16 v[180:181], v21 offset:40960
    ds_read_b64_tr_b16 v[182:183], v21 offset:43008
    ds_read_b64_tr_b16 v[184:185], v13 offset:40960
    ds_read_b64_tr_b16 v[186:187], v13 offset:43008
    ds_read_b64_tr_b16 v[188:189], v14 offset:40960
    ds_read_b64_tr_b16 v[190:191], v14 offset:43008
    ds_read_b64_tr_b16 v[192:193], v15 offset:40960
    ds_read_b64_tr_b16 v[194:195], v15 offset:43008
    ds_read_b64_tr_b16 v[196:197], v21 offset:45056
    ds_read_b64_tr_b16 v[198:199], v21 offset:47104
    ds_read_b64_tr_b16 v[200:201], v13 offset:45056
    ds_read_b64_tr_b16 v[202:203], v13 offset:47104
    ds_read_b64_tr_b16 v[204:205], v14 offset:45056
    ds_read_b64_tr_b16 v[206:207], v14 offset:47104
    ds_read_b64_tr_b16 v[208:209], v15 offset:45056
    ds_read_b64_tr_b16 v[210:211], v15 offset:47104
    ds_read_b64_tr_b16 v[212:213], v21 offset:49152
    ds_read_b64_tr_b16 v[214:215], v21 offset:51200
    ds_read_b64_tr_b16 v[216:217], v13 offset:49152
    ds_read_b64_tr_b16 v[218:219], v13 offset:51200
    ds_read_b64_tr_b16 v[220:221], v14 offset:49152
    ds_read_b64_tr_b16 v[222:223], v14 offset:51200
    ds_read_b64_tr_b16 v[224:225], v15 offset:49152
    ds_read_b64_tr_b16 v[226:227], v15 offset:51200
    ds_read_b64_tr_b16 v[228:229], v21 offset:53248
    ds_read_b64_tr_b16 v[230:231], v21 offset:55296
    ds_read_b64_tr_b16 v[104:105], v13 offset:53248
    ds_read_b64_tr_b16 v[106:107], v13 offset:55296
    ds_read_b64_tr_b16 v[108:109], v14 offset:53248
    ds_read_b64_tr_b16 v[110:111], v14 offset:55296
    ds_read_b64_tr_b16 v[140:141], v15 offset:53248
    ds_read_b64_tr_b16 v[142:143], v15 offset:55296
    s_mul_i32 s52, s3, 28672
    s_add_u32 s52, s52, s63
    s_mov_b64 exec, 0
    s_bitcmp1_b32 s3, 1
    s_cbranch_scc1 L_ihkf_hi
    s_bitcmp1_b32 s3, 0
    s_cbranch_scc1 L_ihkf_1
    s_branch L_ihkf_0
L_ihkf_hi:
    s_bitcmp1_b32 s3, 0
    s_cbranch_scc1 L_ihkf_3
    s_branch L_ihkf_2
L_ihkf_ret:
    s_mov_b64 exec, -1
    s_waitcnt vmcnt(7)
    v_add_u32 v31, 158720, v1
    s_waitcnt lgkmcnt(0)
    s_barrier
    ds_read_b128 v[144:147], v31 offset:0
    ds_read_b128 v[148:151], v31 offset:1024
    ds_read_b128 v[152:155], v31 offset:2048
    ds_read_b128 v[156:159], v31 offset:3072
    s_waitcnt lgkmcnt(0)
    v_max3_u32 v30, v144, v145, v146
    v_max3_u32 v30, v147, v148, v30
    v_max3_u32 v30, v149, v150, v30
    v_max3_u32 v30, v151, v152, v30
    v_max3_u32 v30, v153, v154, v30
    v_max3_u32 v30, v155, v156, v30
    v_max3_u32 v30, v157, v158, v30
    v_max_u32 v30, v159, v30
    v_cmp_eq_u32 vcc, -1, v30
    s_cbranch_vccnz L_retry_7
L_ok_8:
    v_mfma_f32_32x32x16_bf16 v[112:127], v[144:147], v[64:67], 0
    v_mfma_f32_32x32x16_bf16 v[112:127], v[148:151], v[68:71], v[112:127]
    v_mfma_f32_32x32x16_bf16 v[112:127], v[152:155], v[72:75], v[112:127]
    v_mfma_f32_32x32x16_bf16 v[112:127], v[156:159], v[76:79], v[112:127]
    s_lshl_b32 s53, s6, 2
    s_add_u32 s53, s53, s3
    s_mul_i32 s53, s53, 14336
    s_add_u32 s53, s53, s63
    s_add_u32 s54, s53, 4096
    s_add_u32 s55, s53, 8192
    s_add_u32 s72, s53, 12288
    s_nop 4
    v_mov_b32 v30, v124
    v_mov_b32 v92, v124
    s_nop 1
    v_permlane32_swap_b32 v30, v92
    v_add_f32 v92, 0x358637bd, v92
    v_rcp_f32 v92, v92
    s_nop 0
    v_pk_mul_f32 v[112:113], v[112:113], v[92:93] op_sel_hi:[1,0]
    v_pk_mul_f32 v[114:115], v[114:115], v[92:93] op_sel_hi:[1,0]
    v_pk_mul_f32 v[116:117], v[116:117], v[92:93] op_sel_hi:[1,0]
    v_pk_mul_f32 v[118:119], v[118:119], v[92:93] op_sel_hi:[1,0]
    v_pk_mul_f32 v[120:121], v[120:121], v[92:93] op_sel_hi:[1,0]
    v_pk_mul_f32 v[122:123], v[122:123], v[92:93] op_sel_hi:[1,0]
    v_pk_mul_f32 v[124:125], v[124:125], v[92:93] op_sel_hi:[1,0]
    v_pk_mul_f32 v[126:127], v[126:127], v[92:93] op_sel_hi:[1,0]
    v_cvt_pk_bf16_f32 v96, v112, v113
    v_cvt_pk_bf16_f32 v97, v114, v115
    v_cvt_pk_bf16_f32 v98, v116, v117
    v_cvt_pk_bf16_f32 v99, v118, v119
    v_cvt_pk_bf16_f32 v100, v120, v121
    v_cvt_pk_bf16_f32 v101, v122, v123
    v_cvt_pk_bf16_f32 v102, v124, v125
    v_cvt_pk_bf16_f32 v103, v126, v127
    s_cmp_eq_u32 s65, 0
    s_cbranch_scc1 L_slow_9
    buffer_store_dwordx2 v[96:97], v7, s[48:51], s52 offen
    buffer_store_dwordx2 v[98:99], v8, s[48:51], s52 offen
    buffer_store_dwordx2 v[100:101], v26, s[48:51], s52 offen
    s_mov_b32 exec_hi, 0
    buffer_store_dwordx2 v[102:103], v27, s[48:51], s52 offen
    s_mov_b32 exec_hi, -1
L_back_10:
    s_lshr_b32 s92, s67, 2
    s_add_u32 m0, s92, 115712
    s_add_u32 s92, s97, 917504
    s_mov_b32 exec_hi, 0x00ffffff
    buffer_load_dwordx4 v16, s[24:27], s92 offen lds
    buffer_load_dwordx4 v17, s[24:27], s92 offen offset:896 lds
    buffer_load_dwordx4 v18, s[24:27], s92 offen offset:1792 lds
    buffer_load_dwordx4 v25, s[24:27], s92 offen offset:2688 lds
    s_mov_b32 exec_hi, -1
    s_lshr_b32 s92, s67, 2
    s_add_u32 m0, s92, 130048
    s_add_u32 s92, s97, 1146880
    s_mov_b32 exec_hi, 0x00ffffff
    buffer_load_dwordx4 v16, s[24:27], s92 offen lds
    buffer_load_dwordx4 v17, s[24:27], s92 offen offset:896 lds
    buffer_load_dwordx4 v18, s[24:27], s92 offen offset:1792 lds
    buffer_load_dwordx4 v25, s[24:27], s92 offen offset:2688 lds
    s_mov_b32 exec_hi, -1
    s_lshr_b32 s92, s67, 2
    s_add_u32 m0, s92, 144384
    s_add_u32 s92, s97, 1376256
    s_mov_b32 exec_hi, 0x00ffffff
    buffer_load_dwordx4 v16, s[24:27], s92 offen lds
    buffer_load_dwordx4 v17, s[24:27], s92 offen offset:896 lds
L_ihkf_0:
    s_cbranch_execz L_ihkf_ret
    buffer_load_dwordx4 v18, s[24:27], s92 offen offset:1792 lds
    buffer_load_dwordx4 v25, s[24:27], s92 offen offset:2688 lds
    s_mov_b32 exec_hi, -1
    s_cmp_ge_u32 s5, 14
    s_cbranch_scc1 L_skip2
    v_lshlrev_b32 v112, 16, v232
    v_and_b32 v113, 0xffff0000, v232
    v_lshlrev_b32 v114, 16, v233
    v_and_b32 v115, 0xffff0000, v233
    v_lshlrev_b32 v116, 16, v234
    v_and_b32 v117, 0xffff0000, v234
    v_lshlrev_b32 v118, 16, v235
    v_and_b32 v119, 0xffff0000, v235
    v_lshlrev_b32 v120, 16, v236
    v_and_b32 v121, 0xffff0000, v236
    v_lshlrev_b32 v122, 16, v237
    v_and_b32 v123, 0xffff0000, v237
    v_lshlrev_b32 v124, 16, v238
    v_and_b32 v125, 0xffff0000, v238
    v_lshlrev_b32 v126, 16, v239
    v_and_b32 v127, 0xffff0000, v239
    s_lshl_b32 s7, s71, 11
    s_add_u32 s52, s53, s7
    s_add_u32 s52, s52, 114688
    v_and_b32 v88, 15, v0
    v_lshlrev_b32 v88, 6, v88
    v_lshrrev_b32 v31, 5, v0
    v_lshl_add_u32 v88, v31, 2, v88
    s_lshl_b32 s62, s6, 2
    s_add_u32 s62, s62, s3
    s_lshl_b32 s62, s62, 10
    s_lshl_b32 s7, s71, 3
    s_add_u32 s62, s62, s7
    s_add_u32 s62, s62, s63
    s_add_u32 s62, s62, 229376
    buffer_load_dwordx4 v[32:35], v1, s[48:51], s53 offen sc1
    s_mul_i32 s56, s3, 28672
    s_add_u32 s56, s56, s63
    s_add_u32 s56, s56, 114688
    buffer_load_dwordx4 v[36:39], v1, s[48:51], s53 offen offset:1024 sc1
    s_add_u32 s57, s56, 4096
    s_add_u32 s58, s56, 8192
    s_add_u32 s59, s56, 12288
    buffer_load_dwordx4 v[40:43], v1, s[48:51], s53 offen offset:2048 sc1
    s_add_u32 s60, s56, 16384
    s_add_u32 s75, s56, 20480
    s_add_u32 s99, s56, 24576
    buffer_load_dwordx4 v[44:47], v1, s[48:51], s53 offen offset:3072 sc1
    s_lshl_b32 s70, s3, 11
    s_add_u32 s70, s70, s63
    s_add_u32 s70, s70, 229376
    buffer_load_dwordx4 v[48:51], v1, s[48:51], s54 offen sc1
    v_lshrrev_b32 v13, 4, v0
    v_lshlrev_b32 v13, 4, v13
    v_and_b32 v90, 15, v0
    buffer_load_dwordx4 v[52:55], v1, s[48:51], s54 offen offset:1024 sc1
    v_lshl_add_u32 v12, v90, 6, v13
    v_add_u32 v13, 162816, v13
    v_subrev_u32 v24, 48, v0
    buffer_load_dwordx4 v[56:59], v1, s[48:51], s54 offen offset:2048 sc1
    v_ashrrev_i32 v24, 31, v24
    v_lshrrev_b32 v89, 2, v0
    v_mul_u32_u24 v89, 224, v89
    buffer_load_dwordx4 v[60:63], v1, s[48:51], s54 offen offset:3072 sc1
    v_and_b32 v90, 3, v0
    v_lshl_add_u32 v89, v90, 3, v89
    s_lshl_b32 s7, s73, 5
    s_waitcnt vmcnt(3)
    v_max3_u32 v30, v32, v34, v36
    v_max3_u32 v30, v38, v40, v30
    v_max3_u32 v30, v42, v44, v30
    v_max3_u32 v30, v46, v48, v30
    v_max_u32 v30, v50, v30
    v_cmp_eq_u32 vcc, -1, v30
    s_cbranch_vccnz L_retry_11
L_ok_12:
    v_mfma_f32_16x16x32_bf16 v[112:115], a[112:115], v[32:35], v[112:115]
    buffer_load_dwordx4 v[64:67], v1, s[48:51], s55 offen sc1
    v_mfma_f32_16x16x32_bf16 v[116:119], a[116:119], v[32:35], v[116:119]
    s_add_u32 s7, s7, 58368
    v_add_u32 v7, s7, v89
    v_mfma_f32_16x16x32_bf16 v[120:123], a[120:123], v[32:35], v[120:123]
    v_add_u32 v8, 50176, v7
    s_cmp_eq_u32 s73, 0
    s_cselect_b32 s7, 192, 0
    v_mfma_f32_16x16x32_bf16 v[124:127], a[124:127], v[32:35], v[124:127]
    s_add_u32 s7, s7, 58368
    v_add_u32 v5, s7, v89
    v_mfma_f32_16x16x32_bf16 v[112:115], a[128:131], v[36:39], v[112:115]
    buffer_load_dwordx4 v[68:71], v1, s[48:51], s55 offen offset:1024 sc1
    v_mfma_f32_16x16x32_bf16 v[116:119], a[132:135], v[36:39], v[116:119]
    v_add_u32 v6, 50176, v5
    s_add_u32 s61, s3, s73
    v_mfma_f32_16x16x32_bf16 v[120:123], a[136:139], v[36:39], v[120:123]
    s_lshl_b32 s61, s61, 5
    s_add_u32 s61, s61, 58368
    v_mfma_f32_16x16x32_bf16 v[124:127], a[140:143], v[36:39], v[124:127]
    v_add_u32 v14, s61, v89
    s_add_u32 s61, s61, 128
    v_mfma_f32_16x16x32_bf16 v[112:115], a[144:147], v[40:43], v[112:115]
    buffer_load_dwordx4 v[72:75], v1, s[48:51], s55 offen offset:2048 sc1
    v_mfma_f32_16x16x32_bf16 v[116:119], a[148:151], v[40:43], v[116:119]
    s_cmp_ge_u32 s3, 2
    s_cselect_b32 s7, s7, s61
    v_mfma_f32_16x16x32_bf16 v[120:123], a[152:155], v[40:43], v[120:123]
    v_add_u32 v15, s7, v89
    s_lshl_b32 s7, s3, 6
    v_mfma_f32_16x16x32_bf16 v[124:127], a[156:159], v[40:43], v[124:127]
    v_add_u32 v26, s7, v13
    s_add_u32 s7, s3, 4
    v_mfma_f32_16x16x32_bf16 v[112:115], a[160:163], v[44:47], v[112:115]
    buffer_load_dwordx4 v[76:79], v1, s[48:51], s55 offen offset:3072 sc1
    v_mfma_f32_16x16x32_bf16 v[116:119], a[164:167], v[44:47], v[116:119]
    s_min_u32 s7, s7, 6
    s_lshl_b32 s7, s7, 6
    v_mfma_f32_16x16x32_bf16 v[120:123], a[168:171], v[44:47], v[120:123]
    v_add_u32 v27, s7, v13
    v_mfma_f32_16x16x32_bf16 v[124:127], a[172:175], v[44:47], v[124:127]
    v_mfma_f32_16x16x32_bf16 v[112:115], a[176:179], v[48:51], v[112:115]
    buffer_load_dwordx4 v[80:83], v1, s[48:51], s72 offen sc1
    v_mfma_f32_16x16x32_bf16 v[116:119], a[180:183], v[48:51], v[116:119]
    v_mfma_f32_16x16x32_bf16 v[120:123], a[184:187], v[48:51], v[120:123]
    v_mfma_f32_16x16x32_bf16 v[124:127], a[188:191], v[48:51], v[124:127]
    s_waitcnt vmcnt(3)
    v_max3_u32 v30, v52, v54, v56
    v_max3_u32 v30, v58, v60, v30
    v_max3_u32 v30, v62, v64, v30
    v_max3_u32 v30, v66, v68, v30
    v_max_u32 v30, v70, v30
    v_cmp_eq_u32 vcc, -1, v30
    s_cbranch_vccnz L_retry_13
L_ok_14:
    v_mfma_f32_16x16x32_bf16 v[112:115], a[192:195], v[52:55], v[112:115]
    buffer_load_dwordx4 v[84:87], v1, s[48:51], s72 offen offset:1024 sc1
    v_mfma_f32_16x16x32_bf16 v[116:119], a[196:199], v[52:55], v[116:119]
    v_mfma_f32_16x16x32_bf16 v[120:123], a[200:203], v[52:55], v[120:123]
    v_mfma_f32_16x16x32_bf16 v[124:127], a[204:207], v[52:55], v[124:127]
    v_mfma_f32_16x16x32_bf16 v[112:115], a[208:211], v[56:59], v[112:115]
    s_add_u32 m0, s67, 0
    s_add_u32 s92, s66, 0
    buffer_load_dwordx4 v2, s[32:35], s92 offen lds
    v_mfma_f32_16x16x32_bf16 v[116:119], a[212:215], v[56:59], v[116:119]
    v_mfma_f32_16x16x32_bf16 v[120:123], a[216:219], v[56:59], v[120:123]
    v_mfma_f32_16x16x32_bf16 v[124:127], a[220:223], v[56:59], v[124:127]
    v_mfma_f32_16x16x32_bf16 v[112:115], a[224:227], v[60:63], v[112:115]
    buffer_load_dwordx4 v9, s[32:35], s92 offen offset:1024 lds
    v_mfma_f32_16x16x32_bf16 v[116:119], a[228:231], v[60:63], v[116:119]
    v_mfma_f32_16x16x32_bf16 v[120:123], a[232:235], v[60:63], v[120:123]
    v_mfma_f32_16x16x32_bf16 v[124:127], a[236:239], v[60:63], v[124:127]
    v_mfma_f32_16x16x32_bf16 v[112:115], a[240:243], v[64:67], v[112:115]
    buffer_load_dwordx4 v10, s[32:35], s92 offen offset:2048 lds
    v_mfma_f32_16x16x32_bf16 v[116:119], a[244:247], v[64:67], v[116:119]
    v_mfma_f32_16x16x32_bf16 v[120:123], a[248:251], v[64:67], v[120:123]
    v_mfma_f32_16x16x32_bf16 v[124:127], v[160:163], v[64:67], v[124:127]
    v_mfma_f32_16x16x32_bf16 v[112:115], v[164:167], v[68:71], v[112:115]
    buffer_load_dwordx4 v11, s[32:35], s92 offen offset:3072 lds
    v_mfma_f32_16x16x32_bf16 v[116:119], v[168:171], v[68:71], v[116:119]
    v_mfma_f32_16x16x32_bf16 v[120:123], v[172:175], v[68:71], v[120:123]
L_ihkf_1:
    s_cbranch_execz L_ihkf_ret
    v_mfma_f32_16x16x32_bf16 v[124:127], v[176:179], v[68:71], v[124:127]
    s_waitcnt vmcnt(4)
    v_max3_u32 v30, v72, v74, v76
    v_max3_u32 v30, v78, v80, v30
    v_max3_u32 v30, v82, v84, v30
    v_max_u32 v30, v86, v30
    v_cmp_eq_u32 vcc, -1, v30
    s_cbranch_vccnz L_retry_15
L_ok_16:
    v_mfma_f32_16x16x32_bf16 v[112:115], v[180:183], v[72:75], v[112:115]
    s_add_u32 m0, s67, 4096
    s_add_u32 s92, s66, 28672
    buffer_load_dwordx4 v2, s[32:35], s92 offen lds
    v_mfma_f32_16x16x32_bf16 v[116:119], v[184:187], v[72:75], v[116:119]
    v_mfma_f32_16x16x32_bf16 v[120:123], v[188:191], v[72:75], v[120:123]
    v_mfma_f32_16x16x32_bf16 v[124:127], v[192:195], v[72:75], v[124:127]
    v_mfma_f32_16x16x32_bf16 v[112:115], v[196:199], v[76:79], v[112:115]
    buffer_load_dwordx4 v9, s[32:35], s92 offen offset:1024 lds
    v_mfma_f32_16x16x32_bf16 v[116:119], v[200:203], v[76:79], v[116:119]
    v_mfma_f32_16x16x32_bf16 v[120:123], v[204:207], v[76:79], v[120:123]
    v_mfma_f32_16x16x32_bf16 v[124:127], v[208:211], v[76:79], v[124:127]
    v_mfma_f32_16x16x32_bf16 v[112:115], v[212:215], v[80:83], v[112:115]
    buffer_load_dwordx4 v10, s[32:35], s92 offen offset:2048 lds
    v_mfma_f32_16x16x32_bf16 v[116:119], v[216:219], v[80:83], v[116:119]
    v_mfma_f32_16x16x32_bf16 v[120:123], v[220:223], v[80:83], v[120:123]
    v_mfma_f32_16x16x32_bf16 v[124:127], v[224:227], v[80:83], v[124:127]
    v_mfma_f32_16x16x32_bf16 v[112:115], v[228:231], v[84:87], v[112:115]
    buffer_load_dwordx4 v11, s[32:35], s92 offen offset:3072 lds
    v_mfma_f32_16x16x32_bf16 v[116:119], v[104:107], v[84:87], v[116:119]
    v_mfma_f32_16x16x32_bf16 v[120:123], v[108:111], v[84:87], v[120:123]
    v_mfma_f32_16x16x32_bf16 v[124:127], v[140:143], v[84:87], v[124:127]
    s_add_u32 m0, s67, 8192
    s_add_u32 s92, s66, 114688
    buffer_load_dwordx4 v2, s[32:35], s92 offen lds
    s_nop 0
    v_cvt_pk_bf16_f32 v96, v112, v113
    v_cvt_pk_bf16_f32 v97, v114, v115
    v_cvt_pk_bf16_f32 v98, v116, v117
    v_cvt_pk_bf16_f32 v99, v118, v119
    v_cvt_pk_bf16_f32 v100, v120, v121
    v_cvt_pk_bf16_f32 v101, v122, v123
    v_cvt_pk_bf16_f32 v102, v124, v125
    v_cvt_pk_bf16_f32 v103, v126, v127
    s_cmp_eq_u32 s65, 0
    s_cbranch_scc1 L_slow_17
    buffer_store_dwordx4 v[96:99], v1, s[48:51], s52 offen
    buffer_store_dwordx4 v[100:103], v1, s[48:51], s52 offen offset:1024
L_back_18:
    v_dot2_f32_bf16 v28, v96, s64, 0
    v_dot2_f32_bf16 v29, v96, v96, 0
    v_dot2_f32_bf16 v28, v97, s64, v28
    v_dot2_f32_bf16 v29, v97, v97, v29
    v_dot2_f32_bf16 v28, v98, s64, v28
    v_dot2_f32_bf16 v29, v98, v98, v29
    v_dot2_f32_bf16 v28, v99, s64, v28
    v_dot2_f32_bf16 v29, v99, v99, v29
    v_dot2_f32_bf16 v28, v100, s64, v28
    v_dot2_f32_bf16 v29, v100, v100, v29
    v_dot2_f32_bf16 v28, v101, s64, v28
    v_dot2_f32_bf16 v29, v101, v101, v29
    v_dot2_f32_bf16 v28, v102, s64, v28
    v_dot2_f32_bf16 v29, v102, v102, v29
    v_dot2_f32_bf16 v28, v103, s64, v28
    v_dot2_f32_bf16 v29, v103, v103, v29
    s_nop 2
    v_permlane32_swap_b32 v28, v29
    v_add_f32 v28, v28, v29
    v_mov_b32 v29, v28
    s_nop 1
    v_permlane16_swap_b32 v28, v29
    v_add_f32 v28, v28, v29
    s_cmp_eq_u32 s65, 0
    s_cbranch_scc1 L_slow_19
    buffer_store_dword v28, v88, s[48:51], s62 offen
L_back_20:
    buffer_load_dwordx4 v9, s[32:35], s92 offen offset:1024 lds
    buffer_load_dwordx4 v10, s[32:35], s92 offen offset:2048 lds
    buffer_load_dwordx4 v11, s[32:35], s92 offen offset:3072 lds
    s_add_u32 m0, s67, 12288
    s_add_u32 s92, s66, 143360
    buffer_load_dwordx4 v2, s[32:35], s92 offen lds
    buffer_load_dwordx4 v9, s[32:35], s92 offen offset:1024 lds
    s_branch L_join2
L_join2:
    v_mov_b32 v16, s64
    v_mov_b32 v17, s64
    v_mov_b32 v18, s64
    v_mov_b32 v19, s64
    s_mov_b64 exec, 0
    s_bitcmp1_b32 s3, 1
    s_cbranch_scc1 L_ihw1_hi
    s_bitcmp1_b32 s3, 0
    s_cbranch_scc1 L_ihw1_1
    s_branch L_ihw1_0
L_ihw1_hi:
    s_bitcmp1_b32 s3, 0
    s_cbranch_scc1 L_ihw1_3
    s_branch L_ihw1_2
L_ihw1_ret:
    s_mov_b64 exec, -1
    s_waitcnt lgkmcnt(0)
    s_barrier
    v_add_u32 v30, 50176, v14
    v_add_u32 v31, 50176, v15
    ds_read_b64_tr_b16 a[56:57], v14 offset:0
    ds_read_b64_tr_b16 a[58:59], v14 offset:3584
    s_waitcnt vmcnt(15)
    ds_read_b64_tr_b16 a[0:1], v3 offset:0
    ds_read_b64_tr_b16 a[2:3], v3 offset:1024
    ds_read_b64_tr_b16 a[4:5], v4 offset:0
    ds_read_b64_tr_b16 a[6:7], v4 offset:1024
    ds_read_b64_tr_b16 a[60:61], v15 offset:0
    ds_read_b64_tr_b16 a[62:63], v15 offset:3584
    ds_read_b64_tr_b16 a[64:65], v14 offset:7168
    ds_read_b64_tr_b16 a[66:67], v14 offset:10752
    ds_read_b64_tr_b16 a[68:69], v15 offset:7168
    ds_read_b64_tr_b16 a[70:71], v15 offset:10752
    s_waitcnt vmcnt(13)
    ds_read_b64_tr_b16 a[8:9], v3 offset:2048
    ds_read_b64_tr_b16 a[10:11], v3 offset:3072
    ds_read_b64_tr_b16 a[12:13], v4 offset:2048
    ds_read_b64_tr_b16 a[14:15], v4 offset:3072
    ds_read_b64_tr_b16 a[72:73], v14 offset:14336
    ds_read_b64_tr_b16 a[74:75], v14 offset:17920
    ds_read_b64_tr_b16 a[76:77], v15 offset:14336
    ds_read_b64_tr_b16 a[78:79], v15 offset:17920
    ds_read_b64_tr_b16 a[80:81], v14 offset:21504
    ds_read_b64_tr_b16 a[82:83], v14 offset:25088
    s_waitcnt lgkmcnt(15)
    s_add_u32 m0, s67, 0
    s_add_u32 s92, s66, 145408
    buffer_load_dwordx4 v10, s[32:35], s92 offen lds
    buffer_load_dwordx4 v11, s[32:35], s92 offen offset:1024 lds
    v_mfma_f32_16x16x32_bf16 v[240:243], a[56:59], v[16:19], 0
    ds_read_b64_tr_b16 a[84:85], v15 offset:21504
    ds_read_b64_tr_b16 a[86:87], v15 offset:25088
    s_waitcnt lgkmcnt(15)
    v_mfma_f32_16x16x32_bf16 v[244:247], a[60:63], v[16:19], 0
    s_waitcnt vmcnt(13)
    ds_read_b64_tr_b16 a[16:17], v3 offset:4096
    ds_read_b64_tr_b16 a[18:19], v3 offset:5120
    ds_read_b64_tr_b16 a[20:21], v4 offset:4096
    ds_read_b64_tr_b16 a[22:23], v4 offset:5120
    ds_read_b64_tr_b16 a[88:89], v14 offset:28672
    ds_read_b64_tr_b16 a[90:91], v14 offset:32256
    s_waitcnt lgkmcnt(15)
    v_mfma_f32_16x16x32_bf16 v[240:243], a[64:67], v[16:19], v[240:243]
    ds_read_b64_tr_b16 a[92:93], v15 offset:28672
    ds_read_b64_tr_b16 a[94:95], v15 offset:32256
    s_waitcnt lgkmcnt(15)
    s_add_u32 m0, s67, 2048
    s_add_u32 s92, s66, 200704
    buffer_load_dwordx4 v2, s[32:35], s92 offen lds
    buffer_load_dwordx4 v9, s[32:35], s92 offen offset:1024 lds
L_ihkf_2:
    s_cbranch_execz L_ihkf_ret
    v_mfma_f32_16x16x32_bf16 v[244:247], a[68:71], v[16:19], v[244:247]
    ds_read_b64_tr_b16 a[96:97], v14 offset:35840
    ds_read_b64_tr_b16 a[98:99], v14 offset:39424
    s_waitcnt lgkmcnt(15)
    v_mfma_f32_16x16x32_bf16 v[240:243], a[72:75], v[16:19], v[240:243]
    s_waitcnt vmcnt(13)
    ds_read_b64_tr_b16 a[24:25], v3 offset:6144
    ds_read_b64_tr_b16 a[26:27], v3 offset:7168
    ds_read_b64_tr_b16 a[28:29], v4 offset:6144
    ds_read_b64_tr_b16 a[30:31], v4 offset:7168
    ds_read_b64_tr_b16 a[100:101], v15 offset:35840
    ds_read_b64_tr_b16 a[102:103], v15 offset:39424
    s_waitcnt lgkmcnt(15)
    v_mfma_f32_16x16x32_bf16 v[244:247], a[76:79], v[16:19], v[244:247]
    ds_read_b64_tr_b16 a[104:105], v14 offset:43008
    ds_read_b64_tr_b16 a[106:107], v14 offset:46592
    s_waitcnt lgkmcnt(14)
    buffer_load_dwordx4 v10, s[32:35], s92 offen offset:2048 lds
    buffer_load_dwordx4 v11, s[32:35], s92 offen offset:3072 lds
    v_mfma_f32_16x16x32_bf16 v[240:243], a[80:83], v[16:19], v[240:243]
    ds_read_b64_tr_b16 a[108:109], v15 offset:43008
    ds_read_b64_tr_b16 a[110:111], v15 offset:46592
    v_mfma_f32_16x16x32_bf16 v[244:247], a[84:87], v[16:19], v[244:247]
    s_waitcnt vmcnt(10)
    ds_read_b64_tr_b16 a[32:33], v3 offset:8192
    ds_read_b64_tr_b16 a[34:35], v3 offset:9216
    ds_read_b64_tr_b16 a[36:37], v4 offset:8192
    ds_read_b64_tr_b16 a[38:39], v4 offset:9216
    ds_read_b64_tr_b16 a[112:113], v30 offset:0
    ds_read_b64_tr_b16 a[114:115], v30 offset:3584
    s_waitcnt lgkmcnt(15)
    v_mfma_f32_16x16x32_bf16 v[240:243], a[88:91], v[16:19], v[240:243]
    ds_read_b64_tr_b16 a[116:117], v31 offset:0
    ds_read_b64_tr_b16 a[118:119], v31 offset:3584
    s_waitcnt lgkmcnt(14)
    s_add_u32 m0, s67, 6144
    s_add_u32 s92, s66, 229376
    buffer_load_dwordx4 v2, s[32:35], s92 offen lds
    buffer_load_dwordx4 v9, s[32:35], s92 offen offset:1024 lds
    v_mfma_f32_16x16x32_bf16 v[244:247], a[92:95], v[16:19], v[244:247]
    ds_read_b64_tr_b16 a[120:121], v30 offset:7168
    ds_read_b64_tr_b16 a[122:123], v30 offset:10752
    v_mfma_f32_16x16x32_bf16 v[240:243], a[96:99], v[16:19], v[240:243]
    s_waitcnt vmcnt(10)
    ds_read_b64_tr_b16 a[40:41], v3 offset:10240
    ds_read_b64_tr_b16 a[42:43], v3 offset:11264
    ds_read_b64_tr_b16 a[44:45], v4 offset:10240
    ds_read_b64_tr_b16 a[46:47], v4 offset:11264
    ds_read_b64_tr_b16 a[124:125], v31 offset:7168
    ds_read_b64_tr_b16 a[126:127], v31 offset:10752
    s_waitcnt lgkmcnt(15)
    v_mfma_f32_16x16x32_bf16 v[244:247], a[100:103], v[16:19], v[244:247]
    ds_read_b64_tr_b16 a[128:129], v30 offset:14336
    ds_read_b64_tr_b16 a[130:131], v30 offset:17920
    s_waitcnt lgkmcnt(14)
    buffer_load_dwordx4 v10, s[32:35], s92 offen offset:2048 lds
    buffer_load_dwordx4 v11, s[32:35], s92 offen offset:3072 lds
    v_mfma_f32_16x16x32_bf16 v[240:243], a[104:107], v[16:19], v[240:243]
    ds_read_b64_tr_b16 a[132:133], v31 offset:14336
    ds_read_b64_tr_b16 a[134:135], v31 offset:17920
    v_mfma_f32_16x16x32_bf16 v[244:247], a[108:111], v[16:19], v[244:247]
    s_waitcnt vmcnt(10)
    ds_read_b64_tr_b16 a[48:49], v3 offset:12288
    ds_read_b64_tr_b16 a[50:51], v3 offset:13312
    ds_read_b64_tr_b16 a[52:53], v4 offset:12288
    ds_read_b64_tr_b16 a[54:55], v4 offset:13312
    ds_read_b64_tr_b16 a[136:137], v30 offset:21504
    ds_read_b64_tr_b16 a[138:139], v30 offset:25088
    s_waitcnt lgkmcnt(15)
    v_mfma_f32_16x16x32_bf16 v[240:243], a[112:115], v[16:19], v[240:243]
    ds_read_b64_tr_b16 a[140:141], v31 offset:21504
    ds_read_b64_tr_b16 a[142:143], v31 offset:25088
    s_waitcnt lgkmcnt(14)
    s_add_u32 m0, s67, 10240
    s_add_u32 s92, s66, 315392
    buffer_load_dwordx4 v2, s[32:35], s92 offen lds
    buffer_load_dwordx4 v9, s[32:35], s92 offen offset:1024 lds
    v_mfma_f32_16x16x32_bf16 v[244:247], a[116:119], v[16:19], v[244:247]
    ds_read_b64_tr_b16 a[144:145], v30 offset:28672
    ds_read_b64_tr_b16 a[146:147], v30 offset:32256
    v_mfma_f32_16x16x32_bf16 v[240:243], a[120:123], v[16:19], v[240:243]
    s_waitcnt lgkmcnt(6)
    buffer_load_dwordx4 v10, s[32:35], s92 offen offset:2048 lds
    buffer_load_dwordx4 v11, s[32:35], s92 offen offset:3072 lds
    ds_read_b64_tr_b16 a[148:149], v31 offset:28672
    ds_read_b64_tr_b16 a[150:151], v31 offset:32256
    v_mfma_f32_16x16x32_bf16 v[244:247], a[124:127], v[16:19], v[244:247]
    ds_read_b64_tr_b16 a[152:153], v30 offset:35840
    ds_read_b64_tr_b16 a[154:155], v30 offset:39424
    v_mfma_f32_16x16x32_bf16 v[240:243], a[128:131], v[16:19], v[240:243]
    ds_read_b64_tr_b16 a[156:157], v31 offset:35840
    ds_read_b64_tr_b16 a[158:159], v31 offset:39424
    v_mfma_f32_16x16x32_bf16 v[244:247], a[132:135], v[16:19], v[244:247]
    ds_read_b64_tr_b16 a[160:161], v30 offset:43008
    ds_read_b64_tr_b16 a[162:163], v30 offset:46592
    s_waitcnt lgkmcnt(12)
    v_mfma_f32_16x16x32_bf16 v[240:243], a[136:139], v[16:19], v[240:243]
    ds_read_b64_tr_b16 a[164:165], v31 offset:43008
    ds_read_b64_tr_b16 a[166:167], v31 offset:46592
    s_waitcnt lgkmcnt(12)
    v_mfma_f32_16x16x32_bf16 v[244:247], a[140:143], v[16:19], v[244:247]
    ds_read_b64_tr_b16 a[168:169], v7 offset:0
    ds_read_b64_tr_b16 a[170:171], v7 offset:3584
    s_waitcnt lgkmcnt(12)
    v_mfma_f32_16x16x32_bf16 v[240:243], a[144:147], v[16:19], v[240:243]
    ds_read_b64_tr_b16 a[172:173], v7 offset:32
    ds_read_b64_tr_b16 a[174:175], v7 offset:3616
    s_waitcnt lgkmcnt(12)
    v_mfma_f32_16x16x32_bf16 v[244:247], a[148:151], v[16:19], v[244:247]
    ds_read_b64_tr_b16 a[176:177], v7 offset:64
    ds_read_b64_tr_b16 a[178:179], v7 offset:3648
    s_waitcnt lgkmcnt(12)
    v_mfma_f32_16x16x32_bf16 v[240:243], a[152:155], v[16:19], v[240:243]
    ds_read_b64_tr_b16 a[180:181], v7 offset:96
    ds_read_b64_tr_b16 a[182:183], v7 offset:3680
    s_waitcnt lgkmcnt(12)
    v_mfma_f32_16x16x32_bf16 v[244:247], a[156:159], v[16:19], v[244:247]
    ds_read_b64_tr_b16 a[184:185], v7 offset:7168
    ds_read_b64_tr_b16 a[186:187], v7 offset:10752
    s_waitcnt lgkmcnt(12)
    v_mfma_f32_16x16x32_bf16 v[240:243], a[160:163], v[16:19], v[240:243]
    ds_read_b64_tr_b16 a[188:189], v7 offset:7200
    ds_read_b64_tr_b16 a[190:191], v7 offset:10784
    buffer_load_dwordx4 v[248:251], v12, s[48:51], s70 offen sc1
    s_waitcnt lgkmcnt(12)
    v_mfma_f32_16x16x32_bf16 v[244:247], a[164:167], v[16:19], v[244:247]
    buffer_load_dwordx4 v[252:255], v12, s[48:51], s70 offen offset:1024 sc1
    ds_read_b64_tr_b16 a[192:193], v7 offset:7232
    ds_read_b64_tr_b16 a[194:195], v7 offset:10816
    buffer_load_dwordx4 v[128:131], v1, s[48:51], s56 offen sc1
    ds_read_b64_tr_b16 a[196:197], v7 offset:7264
    ds_read_b64_tr_b16 a[198:199], v7 offset:10848
    buffer_load_dwordx4 v[132:135], v1, s[48:51], s59 offen offset:2048 sc1
    s_mov_b32 exec_lo, 0x00010001
    s_mov_b32 exec_hi, 0x00010001
    ds_write_b128 v26, v[240:243]
    ds_write_b128 v27, v[244:247]
    s_mov_b64 exec, -1
    ds_read_b64_tr_b16 a[200:201], v7 offset:14336
L_ihw1_0:
    s_cbranch_execz L_ihw1_ret
    ds_read_b64_tr_b16 a[202:203], v7 offset:17920
    buffer_load_dwordx4 v[136:139], v1, s[48:51], s56 offen offset:1024 sc1
    ds_read_b64_tr_b16 a[204:205], v7 offset:14368
    ds_read_b64_tr_b16 a[206:207], v7 offset:17952
    buffer_load_dwordx4 v[140:143], v1, s[48:51], s59 offen offset:3072 sc1
    ds_read_b64_tr_b16 a[208:209], v7 offset:14400
    ds_read_b64_tr_b16 a[210:211], v7 offset:17984
    buffer_load_dwordx4 v[144:147], v1, s[48:51], s56 offen offset:2048 sc1
    ds_read_b64_tr_b16 a[212:213], v7 offset:14432
    ds_read_b64_tr_b16 a[214:215], v7 offset:18016
    buffer_load_dwordx4 v[148:151], v1, s[48:51], s60 offen sc1
    ds_read_b64_tr_b16 a[216:217], v7 offset:21504
    ds_read_b64_tr_b16 a[218:219], v7 offset:25088
    buffer_load_dwordx4 v[152:155], v1, s[48:51], s56 offen offset:3072 sc1
    ds_read_b64_tr_b16 a[220:221], v7 offset:21536
    ds_read_b64_tr_b16 a[222:223], v7 offset:25120
    buffer_load_dwordx4 v[156:159], v1, s[48:51], s60 offen offset:1024 sc1
    ds_read_b64_tr_b16 a[224:225], v7 offset:21568
    ds_read_b64_tr_b16 a[226:227], v7 offset:25152
    buffer_load_dwordx4 v[160:163], v1, s[48:51], s57 offen sc1
    ds_read_b64_tr_b16 a[228:229], v7 offset:21600
    ds_read_b64_tr_b16 a[230:231], v7 offset:25184
    buffer_load_dwordx4 v[164:167], v1, s[48:51], s60 offen offset:2048 sc1
    ds_read_b64_tr_b16 a[232:233], v7 offset:28672
    ds_read_b64_tr_b16 a[234:235], v7 offset:32256
    ds_read_b64_tr_b16 a[236:237], v7 offset:28704
    ds_read_b64_tr_b16 a[238:239], v7 offset:32288
    ds_read_b64_tr_b16 a[240:241], v7 offset:28736
    ds_read_b64_tr_b16 a[242:243], v7 offset:32320
    ds_read_b64_tr_b16 a[244:245], v7 offset:28768
    ds_read_b64_tr_b16 a[246:247], v7 offset:32352
    s_waitcnt lgkmcnt(15)
    s_barrier
    s_waitcnt vmcnt(6)
    v_and_b32 v250, v250, v24
    v_and_b32 v251, v251, v24
    v_and_b32 v254, v254, v24
    v_and_b32 v255, v255, v24
    v_max3_u32 v30, v128, v130, v132
    v_max3_u32 v30, v134, v136, v30
    v_max3_u32 v30, v138, v140, v30
    v_max3_u32 v30, v142, v248, v30
    v_max3_u32 v30, v249, v250, v30
    v_max3_u32 v30, v251, v252, v30
    v_max3_u32 v30, v253, v254, v30
    v_max_u32 v30, v255, v30
    v_cmp_eq_u32 vcc, -1, v30
    s_cbranch_vccnz L_hre_21
L_hok_22:
    s_mul_i32 s72, s3, 28672
    s_add_u32 s72, s72, s63
    s_lshr_b32 s7, s91, 2
    s_mul_i32 s7, s7, 114688
    s_add_u32 s72, s72, s7
    s_cmp_lg_u32 s7, 0
    s_cselect_b32 s7, 147456, 0
    s_add_u32 s72, s72, s7
    s_and_b32 s7, s91, 3
    s_mul_i32 s7, s7, 7
    s_add_u32 s7, s7, 1
    s_lshr_b32 s7, s7, 1
    s_lshl_b32 s7, s7, 10
    s_add_u32 s72, s72, s7
    v_mfma_f32_16x16x32_bf16 v[32:35], a[168:171], v[128:131], 0
    buffer_load_dwordx4 v[168:171], v1, s[48:51], s57 offen offset:1024 sc1
    v_mfma_f32_16x16x32_bf16 v[36:39], a[168:171], v[132:135], 0
    ds_read_b64_tr_b16 a[168:169], v7 offset:35840
    ds_read_b128 v[240:243], v13 offset:0
    ds_read_b128 v[244:247], v13 offset:448
    v_mfma_f32_16x16x32_bf16 v[40:43], a[172:175], v[128:131], 0
    ds_read_b64_tr_b16 a[170:171], v7 offset:39424
    buffer_load_dwordx4 v[172:175], v1, s[48:51], s60 offen offset:3072 sc1
    v_mfma_f32_16x16x32_bf16 v[44:47], a[172:175], v[132:135], 0
    ds_read_b64_tr_b16 a[172:173], v7 offset:35872
    v_add_f32 v248, v248, v250
    v_add_f32 v249, v249, v251
    v_mfma_f32_16x16x32_bf16 v[48:51], a[176:179], v[128:131], 0
    ds_read_b64_tr_b16 a[174:175], v7 offset:39456
    buffer_load_dwordx4 v[176:179], v1, s[48:51], s57 offen offset:2048 sc1
    v_mfma_f32_16x16x32_bf16 v[52:55], a[176:179], v[132:135], 0
    ds_read_b64_tr_b16 a[176:177], v7 offset:35904
    v_add_f32 v252, v252, v254
    v_add_f32 v253, v253, v255
    v_mfma_f32_16x16x32_bf16 v[56:59], a[180:183], v[128:131], 0
    ds_read_b64_tr_b16 a[178:179], v7 offset:39488
    buffer_load_dwordx4 v[180:183], v1, s[48:51], s75 offen sc1
    v_mfma_f32_16x16x32_bf16 v[60:63], a[180:183], v[132:135], 0
    ds_read_b64_tr_b16 a[180:181], v7 offset:35936
    v_permlane32_swap_b32 v248, v249
    v_permlane32_swap_b32 v252, v253
    v_mfma_f32_16x16x32_bf16 v[32:35], a[184:187], v[136:139], v[32:35]
    ds_read_b64_tr_b16 a[182:183], v7 offset:39520
    buffer_load_dwordx4 v[184:187], v1, s[48:51], s57 offen offset:3072 sc1
    v_mfma_f32_16x16x32_bf16 v[36:39], a[184:187], v[140:143], v[36:39]
    ds_read_b64_tr_b16 a[184:185], v7 offset:43008
    v_add_f32 v248, v248, v249
    v_add_f32 v252, v252, v253
    v_mfma_f32_16x16x32_bf16 v[40:43], a[188:191], v[136:139], v[40:43]
    ds_read_b64_tr_b16 a[186:187], v7 offset:46592
    buffer_load_dwordx4 v[188:191], v1, s[48:51], s75 offen offset:1024 sc1
    v_mfma_f32_16x16x32_bf16 v[44:47], a[188:191], v[140:143], v[44:47]
    ds_read_b64_tr_b16 a[188:189], v7 offset:43040
    s_nop 0
    v_permlane16_swap_b32 v248, v252
    v_mfma_f32_16x16x32_bf16 v[48:51], a[192:195], v[136:139], v[48:51]
    ds_read_b64_tr_b16 a[190:191], v7 offset:46624
    buffer_load_dwordx4 v[192:195], v1, s[48:51], s58 offen sc1
    v_mfma_f32_16x16x32_bf16 v[52:55], a[192:195], v[140:143], v[52:55]
    ds_read_b64_tr_b16 a[192:193], v7 offset:43072
    v_add_f32 v248, v248, v252
    v_mul_f32 v248, 0x3b124925, v248
    v_mfma_f32_16x16x32_bf16 v[56:59], a[196:199], v[136:139], v[56:59]
    ds_read_b64_tr_b16 a[194:195], v7 offset:46656
    buffer_load_dwordx4 v[196:199], v1, s[48:51], s75 offen offset:2048 sc1
    v_mfma_f32_16x16x32_bf16 v[60:63], a[196:199], v[140:143], v[60:63]
    ds_read_b64_tr_b16 a[196:197], v7 offset:43104
    v_mov_b32 v249, v248
    s_nop 0
    s_waitcnt vmcnt(8)
    v_max3_u32 v30, v144, v146, v148
    v_max3_u32 v30, v150, v152, v30
    v_max3_u32 v30, v154, v156, v30
    v_max3_u32 v30, v158, v160, v30
    v_max3_u32 v30, v162, v164, v30
    v_max_u32 v30, v166, v30
    v_cmp_eq_u32 vcc, -1, v30
    s_cbranch_vccnz L_retry_23
L_ok_24:
    v_mfma_f32_16x16x32_bf16 v[32:35], a[200:203], v[144:147], v[32:35]
    ds_read_b64_tr_b16 a[198:199], v7 offset:46688
    buffer_load_dwordx4 v[200:203], v1, s[48:51], s58 offen offset:1024 sc1
    v_mfma_f32_16x16x32_bf16 v[36:39], a[200:203], v[148:151], v[36:39]
    ds_read_b64_tr_b16 a[200:201], v8 offset:0
    v_permlane32_swap_b32 v248, v249
    v_fma_f32 v249, -v248, v248, v249
    v_mfma_f32_16x16x32_bf16 v[40:43], a[204:207], v[144:147], v[40:43]
    ds_read_b64_tr_b16 a[202:203], v8 offset:3584
    buffer_load_dwordx4 v[204:207], v1, s[48:51], s75 offen offset:3072 sc1
    v_mfma_f32_16x16x32_bf16 v[44:47], a[204:207], v[148:151], v[44:47]
    ds_read_b64_tr_b16 a[204:205], v8 offset:32
    v_add_f32 v249, 0x3727c5ac, v249
    v_rsq_f32 v20, v249
    v_mfma_f32_16x16x32_bf16 v[48:51], a[208:211], v[144:147], v[48:51]
    ds_read_b64_tr_b16 a[206:207], v8 offset:3616
    buffer_load_dwordx4 v[208:211], v1, s[48:51], s58 offen offset:2048 sc1
    v_mfma_f32_16x16x32_bf16 v[52:55], a[208:211], v[148:151], v[52:55]
    ds_read_b64_tr_b16 a[208:209], v8 offset:64
    v_sub_f32 v26, 0, v248
    v_mul_f32 v22, v26, v20
    v_mfma_f32_16x16x32_bf16 v[56:59], a[212:215], v[144:147], v[56:59]
    ds_read_b64_tr_b16 a[210:211], v8 offset:3648
    buffer_load_dwordx4 v[212:215], v1, s[48:51], s99 offen sc1
    v_mfma_f32_16x16x32_bf16 v[60:63], a[212:215], v[148:151], v[60:63]
    ds_read_b64_tr_b16 a[212:213], v8 offset:96
    v_mul_f32 v24, v249, v20
    ds_read_b128 v[248:251], v13 offset:64
    ds_read_b128 v[252:255], v13 offset:512
    s_waitcnt lgkmcnt(15)
    v_mfma_f32_16x16x32_bf16 v[32:35], a[216:219], v[152:155], v[32:35]
    ds_read_b64_tr_b16 a[214:215], v8 offset:3680
    buffer_load_dwordx4 v[216:219], v1, s[48:51], s58 offen offset:3072 sc1
    v_mfma_f32_16x16x32_bf16 v[36:39], a[216:219], v[156:159], v[36:39]
    ds_read_b64_tr_b16 a[216:217], v8 offset:7168
    v_mov_b32 v21, v20
    v_mov_b32 v23, v22
    v_mfma_f32_16x16x32_bf16 v[40:43], a[220:223], v[152:155], v[40:43]
    ds_read_b64_tr_b16 a[218:219], v8 offset:10752
    buffer_load_dwordx4 v[220:223], v1, s[48:51], s99 offen offset:1024 sc1
    v_mfma_f32_16x16x32_bf16 v[44:47], a[220:223], v[156:159], v[44:47]
    ds_read_b64_tr_b16 a[220:221], v8 offset:7200
    v_mov_b32 v25, v24
    v_mov_b32 v27, v26
    v_mfma_f32_16x16x32_bf16 v[48:51], a[224:227], v[152:155], v[48:51]
    ds_read_b64_tr_b16 a[222:223], v8 offset:10784
    ds_read_b64_tr_b16 a[56:57], v3 offset:0
    ds_read_b64_tr_b16 a[58:59], v3 offset:1024
    ds_read_b64_tr_b16 a[60:61], v4 offset:0
    ds_read_b64_tr_b16 a[62:63], v4 offset:1024
    v_mfma_f32_16x16x32_bf16 v[52:55], a[224:227], v[156:159], v[52:55]
    ds_read_b64_tr_b16 a[224:225], v8 offset:7232
    v_permlane16_swap_b32 v20, v21
    v_permlane16_swap_b32 v22, v23
    v_mfma_f32_16x16x32_bf16 v[56:59], a[228:231], v[152:155], v[56:59]
    ds_read_b64_tr_b16 a[226:227], v8 offset:10816
    v_permlane16_swap_b32 v24, v25
    v_mfma_f32_16x16x32_bf16 v[60:63], a[228:231], v[156:159], v[60:63]
    ds_read_b64_tr_b16 a[228:229], v8 offset:7264
    v_permlane16_swap_b32 v26, v27
    v_fma_f32 v88, v240, v22, v244
    v_mfma_f32_16x16x32_bf16 v[32:35], a[232:235], v[160:163], v[32:35]
    ds_read_b64_tr_b16 a[230:231], v8 offset:10848
    buffer_load_dwordx4 v[224:227], v1, s[48:51], s59 offen sc1
    v_mfma_f32_16x16x32_bf16 v[36:39], a[232:235], v[164:167], v[36:39]
    ds_read_b64_tr_b16 a[232:233], v8 offset:14336
    v_fma_f32 v89, v241, v22, v245
    v_fma_f32 v90, v242, v22, v246
    v_mfma_f32_16x16x32_bf16 v[40:43], a[236:239], v[160:163], v[40:43]
    ds_read_b64_tr_b16 a[234:235], v8 offset:17920
    buffer_load_dwordx4 v[228:231], v1, s[48:51], s99 offen offset:2048 sc1
    v_mfma_f32_16x16x32_bf16 v[44:47], a[236:239], v[164:167], v[44:47]
    ds_read_b64_tr_b16 a[236:237], v8 offset:14368
    v_fma_f32 v91, v243, v22, v247
    v_fma_f32 v92, v240, v23, v244
    v_mfma_f32_16x16x32_bf16 v[48:51], a[240:243], v[160:163], v[48:51]
    ds_read_b64_tr_b16 a[238:239], v8 offset:17952
    s_waitcnt lgkmcnt(8)
    s_add_u32 m0, s67, 0
    s_add_u32 s92, s66, 344064
    buffer_load_dwordx4 v2, s[32:35], s92 offen lds
    buffer_load_dwordx4 v9, s[32:35], s92 offen offset:1024 lds
    v_mfma_f32_16x16x32_bf16 v[52:55], a[240:243], v[164:167], v[52:55]
    ds_read_b64_tr_b16 a[240:241], v8 offset:14400
    v_fma_f32 v93, v241, v23, v245
    v_fma_f32 v94, v242, v23, v246
    v_mfma_f32_16x16x32_bf16 v[56:59], a[244:247], v[160:163], v[56:59]
    ds_read_b64_tr_b16 a[242:243], v8 offset:17984
    v_fma_f32 v95, v243, v23, v247
    v_mfma_f32_16x16x32_bf16 v[60:63], a[244:247], v[164:167], v[60:63]
    ds_read_b64_tr_b16 a[244:245], v8 offset:14432
    ds_read_b128 v[240:243], v13 offset:128
    ds_read_b128 v[244:247], v13 offset:576
    s_waitcnt vmcnt(12)
    v_max3_u32 v30, v168, v170, v172
    v_max3_u32 v30, v174, v176, v30
    v_max3_u32 v30, v178, v180, v30
    v_max3_u32 v30, v182, v184, v30
    v_max3_u32 v30, v186, v188, v30
    v_max_u32 v30, v190, v30
    v_cmp_eq_u32 vcc, -1, v30
    s_cbranch_vccnz L_retry_25
L_ok_26:
    v_mfma_f32_16x16x32_bf16 v[32:35], a[168:171], v[168:171], v[32:35]
    ds_read_b64_tr_b16 a[246:247], v8 offset:18016
    buffer_load_dwordx4 v[232:235], v1, s[48:51], s59 offen offset:1024 sc1
    v_mfma_f32_16x16x32_bf16 v[36:39], a[168:171], v[172:175], v[36:39]
    ds_read_b64_tr_b16 a[168:169], v8 offset:21504
    v_fma_f32 v96, v248, v22, v252
    v_fma_f32 v97, v249, v22, v253
    v_mfma_f32_16x16x32_bf16 v[40:43], a[172:175], v[168:171], v[40:43]
    ds_read_b64_tr_b16 a[170:171], v8 offset:25088
    buffer_load_dwordx4 v[236:239], v1, s[48:51], s99 offen offset:3072 sc1
    v_lshlrev_b32 v31, 7, v0
    s_mov_b64 exec, 67108863
    s_lshl_b32 s74, s5, 2
    s_add_u32 s74, s74, s3
    s_mul_i32 s74, s74, 3328
    s_add_u32 s74, s74, s63
    s_add_u32 s74, s74, 393216
    buffer_load_dword a255, v31, s[48:51], s74 offen
    s_mov_b64 exec, -1
    v_mfma_f32_16x16x32_bf16 v[44:47], a[172:175], v[172:175], v[44:47]
    ds_read_b64_tr_b16 a[172:173], v8 offset:21536
    v_fma_f32 v98, v250, v22, v254
    v_fma_f32 v99, v251, v22, v255
    v_mfma_f32_16x16x32_bf16 v[48:51], a[176:179], v[168:171], v[48:51]
    ds_read_b64_tr_b16 a[174:175], v8 offset:25120
    ds_read_b64_tr_b16 a[64:65], v3 offset:2048
    ds_read_b64_tr_b16 a[66:67], v3 offset:3072
    ds_read_b64_tr_b16 a[68:69], v4 offset:2048
    ds_read_b64_tr_b16 a[70:71], v4 offset:3072
    v_mfma_f32_16x16x32_bf16 v[52:55], a[176:179], v[172:175], v[52:55]
    ds_read_b64_tr_b16 a[176:177], v8 offset:21568
    v_fma_f32 v100, v248, v23, v252
    v_fma_f32 v101, v249, v23, v253
    v_mfma_f32_16x16x32_bf16 v[56:59], a[180:183], v[168:171], v[56:59]
    ds_read_b64_tr_b16 a[178:179], v8 offset:25152
    v_fma_f32 v102, v250, v23, v254
    v_mfma_f32_16x16x32_bf16 v[60:63], a[180:183], v[172:175], v[60:63]
    ds_read_b64_tr_b16 a[180:181], v8 offset:21600
    v_fma_f32 v103, v251, v23, v255
    ds_read_b128 v[248:251], v13 offset:192
    ds_read_b128 v[252:255], v13 offset:640
    v_mfma_f32_16x16x32_bf16 v[32:35], a[184:187], v[176:179], v[32:35]
    ds_read_b64_tr_b16 a[182:183], v8 offset:25184
    s_waitcnt lgkmcnt(6)
    buffer_load_dwordx4 v10, s[32:35], s92 offen offset:2048 lds
    buffer_load_dwordx4 v11, s[32:35], s92 offen offset:3072 lds
    v_mfma_f32_16x16x32_bf16 v[36:39], a[184:187], v[180:183], v[36:39]
    ds_read_b64_tr_b16 a[184:185], v8 offset:28672
    v_fma_f32 v104, v240, v22, v244
    v_fma_f32 v105, v241, v22, v245
    v_mfma_f32_16x16x32_bf16 v[40:43], a[188:191], v[176:179], v[40:43]
    ds_read_b64_tr_b16 a[186:187], v8 offset:32256
    v_fma_f32 v106, v242, v22, v246
    v_mfma_f32_16x16x32_bf16 v[44:47], a[188:191], v[180:183], v[44:47]
    ds_read_b64_tr_b16 a[188:189], v8 offset:28704
    v_fma_f32 v107, v243, v22, v247
    v_fma_f32 v108, v240, v23, v244
    v_mfma_f32_16x16x32_bf16 v[48:51], a[192:195], v[176:179], v[48:51]
    ds_read_b64_tr_b16 a[190:191], v8 offset:32288
    ds_read_b64_tr_b16 a[72:73], v3 offset:4096
L_ihkf_3:
    s_cbranch_execz L_ihkf_ret
    ds_read_b64_tr_b16 a[74:75], v3 offset:5120
    ds_read_b64_tr_b16 a[76:77], v4 offset:4096
    ds_read_b64_tr_b16 a[78:79], v4 offset:5120
    v_mfma_f32_16x16x32_bf16 v[52:55], a[192:195], v[180:183], v[52:55]
    ds_read_b64_tr_b16 a[192:193], v8 offset:28736
    v_fma_f32 v109, v241, v23, v245
    v_fma_f32 v110, v242, v23, v246
    v_mfma_f32_16x16x32_bf16 v[56:59], a[196:199], v[176:179], v[56:59]
    ds_read_b64_tr_b16 a[194:195], v8 offset:32320
    v_fma_f32 v111, v243, v23, v247
    v_mfma_f32_16x16x32_bf16 v[60:63], a[196:199], v[180:183], v[60:63]
    ds_read_b64_tr_b16 a[196:197], v8 offset:28768
    ds_read_b128 v[240:243], v13 offset:256
    ds_read_b128 v[244:247], v13 offset:704
    v_mfma_f32_16x16x32_bf16 v[32:35], a[200:203], v[184:187], v[32:35]
    ds_read_b64_tr_b16 a[198:199], v8 offset:32352
    s_waitcnt lgkmcnt(6)
    s_add_u32 m0, s67, 4096
    s_add_u32 s92, s66, 57344
    buffer_load_dwordx4 v2, s[32:35], s92 offen lds
    buffer_load_dwordx4 v9, s[32:35], s92 offen offset:1024 lds
    v_mfma_f32_16x16x32_bf16 v[36:39], a[200:203], v[188:191], v[36:39]
    ds_read_b64_tr_b16 a[200:201], v8 offset:35840
    v_fma_f32 v112, v248, v22, v252
    v_fma_f32 v113, v249, v22, v253
    v_mfma_f32_16x16x32_bf16 v[40:43], a[204:207], v[184:187], v[40:43]
    ds_read_b64_tr_b16 a[202:203], v8 offset:39424
    v_fma_f32 v114, v250, v22, v254
    v_mfma_f32_16x16x32_bf16 v[44:47], a[204:207], v[188:191], v[44:47]
    ds_read_b64_tr_b16 a[204:205], v8 offset:35872
    v_fma_f32 v115, v251, v22, v255
    v_fma_f32 v116, v248, v23, v252
    v_mfma_f32_16x16x32_bf16 v[48:51], a[208:211], v[184:187], v[48:51]
    ds_read_b64_tr_b16 a[206:207], v8 offset:39456
    ds_read_b64_tr_b16 a[80:81], v3 offset:6144
    ds_read_b64_tr_b16 a[82:83], v3 offset:7168
    ds_read_b64_tr_b16 a[84:85], v4 offset:6144
    ds_read_b64_tr_b16 a[86:87], v4 offset:7168
    v_mfma_f32_16x16x32_bf16 v[52:55], a[208:211], v[188:191], v[52:55]
    ds_read_b64_tr_b16 a[208:209], v8 offset:35904
    v_fma_f32 v117, v249, v23, v253
    v_fma_f32 v118, v250, v23, v254
    v_mfma_f32_16x16x32_bf16 v[56:59], a[212:215], v[184:187], v[56:59]
    ds_read_b64_tr_b16 a[210:211], v8 offset:39488
    v_fma_f32 v119, v251, v23, v255
    v_mfma_f32_16x16x32_bf16 v[60:63], a[212:215], v[188:191], v[60:63]
    ds_read_b64_tr_b16 a[212:213], v8 offset:35936
    ds_read_b128 v[248:251], v13 offset:320
    ds_read_b128 v[252:255], v13 offset:768
    s_waitcnt vmcnt(13)
    v_max3_u32 v30, v192, v194, v196
    v_max3_u32 v30, v198, v200, v30
    v_max3_u32 v30, v202, v204, v30
    v_max3_u32 v30, v206, v208, v30
    v_max3_u32 v30, v210, v212, v30
    v_max_u32 v30, v214, v30
    v_cmp_eq_u32 vcc, -1, v30
    s_cbranch_vccnz L_retry_27
L_ok_28:
    v_mfma_f32_16x16x32_bf16 v[32:35], a[216:219], v[192:195], v[32:35]
    ds_read_b64_tr_b16 a[214:215], v8 offset:39520
    s_waitcnt lgkmcnt(6)
    buffer_load_dwordx4 v10, s[32:35], s92 offen offset:2048 lds
    buffer_load_dwordx4 v11, s[32:35], s92 offen offset:3072 lds
    v_mfma_f32_16x16x32_bf16 v[36:39], a[216:219], v[196:199], v[36:39]
    ds_read_b64_tr_b16 a[216:217], v8 offset:43008
    v_mul_f32 v64, v244, v24
    v_fma_f32 v64, v240, v26, v64
    v_mfma_f32_16x16x32_bf16 v[40:43], a[220:223], v[192:195], v[40:43]
    ds_read_b64_tr_b16 a[218:219], v8 offset:46592
    v_mul_f32 v65, v245, v24
    v_mfma_f32_16x16x32_bf16 v[44:47], a[220:223], v[196:199], v[44:47]
    ds_read_b64_tr_b16 a[220:221], v8 offset:43040
    v_fma_f32 v65, v241, v26, v65
    v_mul_f32 v66, v246, v24
    v_mfma_f32_16x16x32_bf16 v[48:51], a[224:227], v[192:195], v[48:51]
    ds_read_b64_tr_b16 a[222:223], v8 offset:46624
    ds_read_b64_tr_b16 a[88:89], v3 offset:8192
    ds_read_b64_tr_b16 a[90:91], v3 offset:9216
    ds_read_b64_tr_b16 a[92:93], v4 offset:8192
    ds_read_b64_tr_b16 a[94:95], v4 offset:9216
    v_mfma_f32_16x16x32_bf16 v[52:55], a[224:227], v[196:199], v[52:55]
    ds_read_b64_tr_b16 a[224:225], v8 offset:43072
    v_fma_f32 v66, v242, v26, v66
    v_mul_f32 v67, v247, v24
    v_mfma_f32_16x16x32_bf16 v[56:59], a[228:231], v[192:195], v[56:59]
    ds_read_b64_tr_b16 a[226:227], v8 offset:46656
    v_fma_f32 v67, v243, v26, v67
    v_mfma_f32_16x16x32_bf16 v[60:63], a[228:231], v[196:199], v[60:63]
    ds_read_b64_tr_b16 a[228:229], v8 offset:43104
    v_mul_f32 v68, v244, v25
    v_fma_f32 v68, v240, v27, v68
    v_mfma_f32_16x16x32_bf16 v[32:35], a[232:235], v[200:203], v[32:35]
    ds_read_b64_tr_b16 a[230:231], v8 offset:46688
    s_waitcnt lgkmcnt(4)
    s_add_u32 m0, s67, 8192
    s_add_u32 s92, s66, 172032
    buffer_load_dwordx4 v2, s[32:35], s92 offen lds
    buffer_load_dwordx4 v9, s[32:35], s92 offen offset:1024 lds
    v_mfma_f32_16x16x32_bf16 v[36:39], a[232:235], v[204:207], v[36:39]
    ds_read_b64_tr_b16 a[232:233], v7 offset:128
    v_mul_f32 v69, v245, v25
    v_fma_f32 v69, v241, v27, v69
    v_mfma_f32_16x16x32_bf16 v[40:43], a[236:239], v[200:203], v[40:43]
    ds_read_b64_tr_b16 a[234:235], v7 offset:3712
    v_mul_f32 v70, v246, v25
    v_mfma_f32_16x16x32_bf16 v[44:47], a[236:239], v[204:207], v[44:47]
    ds_read_b64_tr_b16 a[236:237], v7 offset:160
    v_fma_f32 v70, v242, v27, v70
    v_mul_f32 v71, v247, v25
    v_mfma_f32_16x16x32_bf16 v[48:51], a[240:243], v[200:203], v[48:51]
    ds_read_b64_tr_b16 a[238:239], v7 offset:3744
    ds_read_b64_tr_b16 a[96:97], v3 offset:10240
    ds_read_b64_tr_b16 a[98:99], v3 offset:11264
    ds_read_b64_tr_b16 a[100:101], v4 offset:10240
    ds_read_b64_tr_b16 a[102:103], v4 offset:11264
    v_mfma_f32_16x16x32_bf16 v[52:55], a[240:243], v[204:207], v[52:55]
    ds_read_b64_tr_b16 a[240:241], v7 offset:7296
    v_fma_f32 v71, v243, v27, v71
    ds_read_b128 v[240:243], v13 offset:384
    ds_read_b128 v[244:247], v13 offset:832
    v_mfma_f32_16x16x32_bf16 v[56:59], a[244:247], v[200:203], v[56:59]
    ds_read_b64_tr_b16 a[242:243], v7 offset:10880
    v_mul_f32 v72, v252, v24
    v_mfma_f32_16x16x32_bf16 v[60:63], a[244:247], v[204:207], v[60:63]
    ds_read_b64_tr_b16 a[244:245], v7 offset:7328
    v_fma_f32 v72, v248, v26, v72
    v_mul_f32 v73, v253, v24
    v_mfma_f32_16x16x32_bf16 v[32:35], a[168:171], v[208:211], v[32:35]
    ds_read_b64_tr_b16 a[246:247], v7 offset:10912
    s_waitcnt lgkmcnt(6)
    buffer_load_dwordx4 v10, s[32:35], s92 offen offset:2048 lds
    buffer_load_dwordx4 v11, s[32:35], s92 offen offset:3072 lds
    v_mfma_f32_16x16x32_bf16 v[36:39], a[168:171], v[212:215], v[36:39]
    ds_read_b64_tr_b16 a[168:169], v7 offset:14464
    v_fma_f32 v73, v249, v26, v73
    v_mul_f32 v74, v254, v24
    v_mfma_f32_16x16x32_bf16 v[40:43], a[172:175], v[208:211], v[40:43]
    ds_read_b64_tr_b16 a[170:171], v7 offset:18048
    v_fma_f32 v74, v250, v26, v74
    v_mfma_f32_16x16x32_bf16 v[44:47], a[172:175], v[212:215], v[44:47]
    ds_read_b64_tr_b16 a[172:173], v7 offset:14496
    v_mul_f32 v75, v255, v24
    v_fma_f32 v75, v251, v26, v75
    v_mfma_f32_16x16x32_bf16 v[48:51], a[176:179], v[208:211], v[48:51]
    ds_read_b64_tr_b16 a[174:175], v7 offset:18080
    ds_read_b64_tr_b16 a[104:105], v3 offset:12288
    ds_read_b64_tr_b16 a[106:107], v3 offset:13312
    ds_read_b64_tr_b16 a[108:109], v4 offset:12288
    ds_read_b64_tr_b16 a[110:111], v4 offset:13312
    v_mfma_f32_16x16x32_bf16 v[52:55], a[176:179], v[212:215], v[52:55]
    ds_read_b64_tr_b16 a[176:177], v7 offset:21632
    v_mul_f32 v76, v252, v25
    v_fma_f32 v76, v248, v27, v76
    v_mfma_f32_16x16x32_bf16 v[56:59], a[180:183], v[208:211], v[56:59]
    ds_read_b64_tr_b16 a[178:179], v7 offset:25216
    v_mul_f32 v77, v253, v25
    v_mfma_f32_16x16x32_bf16 v[60:63], a[180:183], v[212:215], v[60:63]
    ds_read_b64_tr_b16 a[180:181], v7 offset:21664
    v_fma_f32 v77, v249, v27, v77
    v_mul_f32 v78, v254, v25
    s_waitcnt vmcnt(11)
    v_max3_u32 v30, v216, v218, v220
    v_max3_u32 v30, v222, v224, v30
    v_max3_u32 v30, v226, v228, v30
    v_max3_u32 v30, v230, v232, v30
    v_max3_u32 v30, v234, v236, v30
    v_max_u32 v30, v238, v30
    v_cmp_eq_u32 vcc, -1, v30
    s_cbranch_vccnz L_retry_29
L_ok_30:
    v_mfma_f32_16x16x32_bf16 v[32:35], a[184:187], v[216:219], v[32:35]
    ds_read_b64_tr_b16 a[182:183], v7 offset:25248
    s_waitcnt lgkmcnt(4)
    s_add_u32 m0, s67, 12288
    s_add_u32 s92, s66, 258048
    buffer_load_dwordx4 v2, s[32:35], s92 offen lds
    buffer_load_dwordx4 v9, s[32:35], s92 offen offset:1024 lds
    v_mfma_f32_16x16x32_bf16 v[36:39], a[184:187], v[220:223], v[36:39]
    ds_read_b64_tr_b16 a[184:185], v7 offset:28800
    v_fma_f32 v78, v250, v27, v78
    v_mul_f32 v79, v255, v25
    v_mfma_f32_16x16x32_bf16 v[40:43], a[188:191], v[216:219], v[40:43]
    ds_read_b64_tr_b16 a[186:187], v7 offset:32384
    v_fma_f32 v79, v251, v27, v79
    v_mfma_f32_16x16x32_bf16 v[44:47], a[188:191], v[220:223], v[44:47]
    ds_read_b64_tr_b16 a[188:189], v7 offset:28832
    v_mul_f32 v80, v244, v24
    v_fma_f32 v80, v240, v26, v80
    v_mfma_f32_16x16x32_bf16 v[48:51], a[192:195], v[216:219], v[48:51]
    ds_read_b64_tr_b16 a[190:191], v7 offset:32416
    ds_read_b64_tr_b16 a[112:113], v3 offset:0
    ds_read_b64_tr_b16 a[114:115], v3 offset:1024
    ds_read_b64_tr_b16 a[116:117], v4 offset:0
    ds_read_b64_tr_b16 a[118:119], v4 offset:1024
    v_mfma_f32_16x16x32_bf16 v[52:55], a[192:195], v[220:223], v[52:55]
    ds_read_b64_tr_b16 a[192:193], v7 offset:35968
    v_mul_f32 v81, v245, v24
    v_fma_f32 v81, v241, v26, v81
    v_mfma_f32_16x16x32_bf16 v[56:59], a[196:199], v[216:219], v[56:59]
    ds_read_b64_tr_b16 a[194:195], v7 offset:39552
    v_mul_f32 v82, v246, v24
    v_mfma_f32_16x16x32_bf16 v[60:63], a[196:199], v[220:223], v[60:63]
    ds_read_b64_tr_b16 a[196:197], v7 offset:36000
    v_fma_f32 v82, v242, v26, v82
    v_mul_f32 v83, v247, v24
    v_mfma_f32_16x16x32_bf16 v[32:35], a[200:203], v[224:227], v[32:35]
    ds_read_b64_tr_b16 a[198:199], v7 offset:39584
    s_waitcnt lgkmcnt(4)
    s_add_u32 m0, s67, 0
    s_add_u32 s92, s66, 260096
    buffer_load_dwordx4 v10, s[32:35], s92 offen lds
    buffer_load_dwordx4 v11, s[32:35], s92 offen offset:1024 lds
    v_mfma_f32_16x16x32_bf16 v[36:39], a[200:203], v[228:231], v[36:39]
    ds_read_b64_tr_b16 a[200:201], v7 offset:43136
    v_fma_f32 v83, v243, v26, v83
    v_mul_f32 v84, v244, v25
    v_mfma_f32_16x16x32_bf16 v[40:43], a[204:207], v[224:227], v[40:43]
    ds_read_b64_tr_b16 a[202:203], v7 offset:46720
    v_fma_f32 v84, v240, v27, v84
    v_mfma_f32_16x16x32_bf16 v[44:47], a[204:207], v[228:231], v[44:47]
    ds_read_b64_tr_b16 a[204:205], v7 offset:43168
    v_mul_f32 v85, v245, v25
    v_fma_f32 v85, v241, v27, v85
    v_mfma_f32_16x16x32_bf16 v[48:51], a[208:211], v[224:227], v[48:51]
    ds_read_b64_tr_b16 a[206:207], v7 offset:46752
    s_waitcnt vmcnt(12)
    ds_read_b64_tr_b16 a[120:121], v3 offset:2048
    ds_read_b64_tr_b16 a[122:123], v3 offset:3072
    ds_read_b64_tr_b16 a[124:125], v4 offset:2048
    ds_read_b64_tr_b16 a[126:127], v4 offset:3072
    v_mfma_f32_16x16x32_bf16 v[52:55], a[208:211], v[228:231], v[52:55]
    ds_read_b64_tr_b16 a[208:209], v8 offset:128
    v_mul_f32 v86, v246, v25
    v_fma_f32 v86, v242, v27, v86
    v_mfma_f32_16x16x32_bf16 v[56:59], a[212:215], v[224:227], v[56:59]
    ds_read_b64_tr_b16 a[210:211], v8 offset:3712
    v_mul_f32 v87, v247, v25
    v_mfma_f32_16x16x32_bf16 v[60:63], a[212:215], v[228:231], v[60:63]
    ds_read_b64_tr_b16 a[212:213], v8 offset:160
    v_fma_f32 v87, v243, v27, v87
    v_mfma_f32_16x16x32_bf16 v[32:35], a[216:219], v[232:235], v[32:35]
    ds_read_b64_tr_b16 a[214:215], v8 offset:3744
    s_waitcnt lgkmcnt(4)
    s_add_u32 m0, s67, 2048
    s_add_u32 s92, s66, 372736
    buffer_load_dwordx4 v2, s[32:35], s92 offen lds
    buffer_load_dwordx4 v9, s[32:35], s92 offen offset:1024 lds
    v_mfma_f32_16x16x32_bf16 v[36:39], a[216:219], v[236:239], v[36:39]
    ds_read_b64_tr_b16 a[216:217], v8 offset:7296
    v_mfma_f32_16x16x32_bf16 v[40:43], a[220:223], v[232:235], v[40:43]
    ds_read_b64_tr_b16 a[218:219], v8 offset:10880
    v_mfma_f32_16x16x32_bf16 v[44:47], a[220:223], v[236:239], v[44:47]
    ds_read_b64_tr_b16 a[220:221], v8 offset:7328
    v_mfma_f32_16x16x32_bf16 v[48:51], a[224:227], v[232:235], v[48:51]
    ds_read_b64_tr_b16 a[222:223], v8 offset:10912
    s_waitcnt vmcnt(12)
    ds_read_b64_tr_b16 a[128:129], v3 offset:4096
    ds_read_b64_tr_b16 a[130:131], v3 offset:5120
    ds_read_b64_tr_b16 a[132:133], v4 offset:4096
    ds_read_b64_tr_b16 a[134:135], v4 offset:5120
    v_mfma_f32_16x16x32_bf16 v[52:55], a[224:227], v[236:239], v[52:55]
    ds_read_b64_tr_b16 a[224:225], v8 offset:14464
    v_mfma_f32_16x16x32_bf16 v[56:59], a[228:231], v[232:235], v[56:59]
    ds_read_b64_tr_b16 a[226:227], v8 offset:18048
    v_mfma_f32_16x16x32_bf16 v[60:63], a[228:231], v[236:239], v[60:63]
    ds_read_b64_tr_b16 a[228:229], v8 offset:14496
    s_mul_i32 s7, s73, 4088
    s_add_u32 s62, s72, 3072
    s_sub_u32 s62, s62, s7
    s_lshl_b32 s70, s91, 2
    s_add_u32 s70, s70, s3
    s_lshl_b32 s70, s70, 2
    s_add_u32 s70, s70, s63
    s_add_u32 s70, s70, 237568
    v_mfma_f32_16x16x32_bf16 v[64:67], a[232:235], v[128:131], v[64:67]
    ds_read_b64_tr_b16 a[230:231], v8 offset:18080
    s_waitcnt lgkmcnt(4)
    buffer_load_dwordx4 v10, s[32:35], s92 offen offset:2048 lds
    buffer_load_dwordx4 v11, s[32:35], s92 offen offset:3072 lds
    v_mfma_f32_16x16x32_bf16 v[68:71], a[232:235], v[132:135], v[68:71]
    ds_read_b64_tr_b16 a[232:233], v8 offset:21632
    v_fma_f32 v32, v32, v20, v88
    v_fma_f32 v33, v33, v20, v89
    v_mfma_f32_16x16x32_bf16 v[72:75], a[236:239], v[128:131], v[72:75]
    ds_read_b64_tr_b16 a[234:235], v8 offset:25216
    v_fma_f32 v34, v34, v20, v90
    v_fma_f32 v35, v35, v20, v91
    v_mfma_f32_16x16x32_bf16 v[76:79], a[236:239], v[132:135], v[76:79]
    ds_read_b64_tr_b16 a[236:237], v8 offset:21664
    v_max_f32 v32, 0, v32
    v_max_f32 v33, 0, v33
    v_mfma_f32_16x16x32_bf16 v[64:67], a[240:243], v[136:139], v[64:67]
    ds_read_b64_tr_b16 a[238:239], v8 offset:25248
    s_waitcnt vmcnt(12)
    ds_read_b64_tr_b16 a[136:137], v3 offset:6144
    ds_read_b64_tr_b16 a[138:139], v3 offset:7168
    ds_read_b64_tr_b16 a[140:141], v4 offset:6144
    ds_read_b64_tr_b16 a[142:143], v4 offset:7168
    v_mfma_f32_16x16x32_bf16 v[68:71], a[240:243], v[140:143], v[68:71]
    ds_read_b64_tr_b16 a[240:241], v8 offset:28800
    v_max_f32 v34, 0, v34
    v_max_f32 v35, 0, v35
    v_mfma_f32_16x16x32_bf16 v[72:75], a[244:247], v[136:139], v[72:75]
    ds_read_b64_tr_b16 a[242:243], v8 offset:32384
    v_mul_f32 v32, v32, v32
    v_mul_f32 v33, v33, v33
    v_mfma_f32_16x16x32_bf16 v[76:79], a[244:247], v[140:143], v[76:79]
    ds_read_b64_tr_b16 a[244:245], v8 offset:28832
    v_mul_f32 v34, v34, v34
    v_mul_f32 v35, v35, v35
    v_mfma_f32_16x16x32_bf16 v[64:67], a[168:171], v[144:147], v[64:67]
    ds_read_b64_tr_b16 a[246:247], v8 offset:32416
    s_waitcnt lgkmcnt(4)
    s_add_u32 m0, s67, 6144
    s_add_u32 s92, s66, 86016
    buffer_load_dwordx4 v2, s[32:35], s92 offen lds
    buffer_load_dwordx4 v9, s[32:35], s92 offen offset:1024 lds
    v_mfma_f32_16x16x32_bf16 v[68:71], a[168:171], v[148:151], v[68:71]
    ds_read_b64_tr_b16 a[168:169], v8 offset:35968
    v_cvt_pk_bf16_f32 v240, v32, v33
    v_cvt_pk_bf16_f32 v241, v34, v35
    v_mfma_f32_16x16x32_bf16 v[72:75], a[172:175], v[144:147], v[72:75]
    ds_read_b64_tr_b16 a[170:171], v8 offset:39552
    v_fma_f32 v40, v40, v20, v96
    v_fma_f32 v41, v41, v20, v97
    v_mfma_f32_16x16x32_bf16 v[76:79], a[172:175], v[148:151], v[76:79]
    ds_read_b64_tr_b16 a[172:173], v8 offset:36000
    v_fma_f32 v42, v42, v20, v98
    v_fma_f32 v43, v43, v20, v99
    v_mfma_f32_16x16x32_bf16 v[64:67], a[176:179], v[152:155], v[64:67]
    ds_read_b64_tr_b16 a[174:175], v8 offset:39584
    s_waitcnt vmcnt(12)
    ds_read_b64_tr_b16 a[144:145], v3 offset:8192
    ds_read_b64_tr_b16 a[146:147], v3 offset:9216
    ds_read_b64_tr_b16 a[148:149], v4 offset:8192
    ds_read_b64_tr_b16 a[150:151], v4 offset:9216
    v_mfma_f32_16x16x32_bf16 v[68:71], a[176:179], v[156:159], v[68:71]
    ds_read_b64_tr_b16 a[176:177], v8 offset:43136
    v_max_f32 v40, 0, v40
    v_max_f32 v41, 0, v41
    v_mfma_f32_16x16x32_bf16 v[72:75], a[180:183], v[152:155], v[72:75]
    ds_read_b64_tr_b16 a[178:179], v8 offset:46720
    v_max_f32 v42, 0, v42
    v_max_f32 v43, 0, v43
    v_mfma_f32_16x16x32_bf16 v[76:79], a[180:183], v[156:159], v[76:79]
    ds_read_b64_tr_b16 a[180:181], v8 offset:43168
    v_mul_f32 v40, v40, v40
    v_mul_f32 v41, v41, v41
    v_mfma_f32_16x16x32_bf16 v[64:67], a[184:187], v[160:163], v[64:67]
    ds_read_b64_tr_b16 a[182:183], v8 offset:46752
    s_waitcnt lgkmcnt(4)
    buffer_load_dwordx4 v10, s[32:35], s92 offen offset:2048 lds
    buffer_load_dwordx4 v11, s[32:35], s92 offen offset:3072 lds
    v_mfma_f32_16x16x32_bf16 v[68:71], a[184:187], v[164:167], v[68:71]
    ds_read_b64_tr_b16 a[184:185], v5 offset:0
    v_mul_f32 v42, v42, v42
    v_mul_f32 v43, v43, v43
    v_mfma_f32_16x16x32_bf16 v[72:75], a[188:191], v[160:163], v[72:75]
    ds_read_b64_tr_b16 a[186:187], v5 offset:3584
    v_cvt_pk_bf16_f32 v242, v40, v41
    v_cvt_pk_bf16_f32 v243, v42, v43
    v_mfma_f32_16x16x32_bf16 v[76:79], a[188:191], v[164:167], v[76:79]
    ds_read_b64_tr_b16 a[188:189], v5 offset:7168
    s_cmp_eq_u32 s65, 0
    s_cbranch_scc1 L_slow_31
    s_add_u32 s61, s72, 0
    buffer_store_dwordx4 v[240:243], v1, s[48:51], s61 offen
L_back_32:
    v_mfma_f32_16x16x32_bf16 v[64:67], a[192:195], v[168:171], v[64:67]
    ds_read_b64_tr_b16 a[190:191], v5 offset:10752
    s_waitcnt vmcnt(13)
    ds_read_b64_tr_b16 a[152:153], v3 offset:10240
    ds_read_b64_tr_b16 a[154:155], v3 offset:11264
    ds_read_b64_tr_b16 a[156:157], v4 offset:10240
    ds_read_b64_tr_b16 a[158:159], v4 offset:11264
    v_mfma_f32_16x16x32_bf16 v[68:71], a[192:195], v[172:175], v[68:71]
    ds_read_b64_tr_b16 a[192:193], v5 offset:14336
    v_fma_f32 v36, v36, v21, v92
    v_fma_f32 v37, v37, v21, v93
    v_mfma_f32_16x16x32_bf16 v[72:75], a[196:199], v[168:171], v[72:75]
    ds_read_b64_tr_b16 a[194:195], v5 offset:17920
    v_fma_f32 v38, v38, v21, v94
    v_fma_f32 v39, v39, v21, v95
    v_mfma_f32_16x16x32_bf16 v[76:79], a[196:199], v[172:175], v[76:79]
    ds_read_b64_tr_b16 a[196:197], v5 offset:21504
    v_max_f32 v36, 0, v36
    v_max_f32 v37, 0, v37
    v_mfma_f32_16x16x32_bf16 v[64:67], a[200:203], v[176:179], v[64:67]
    ds_read_b64_tr_b16 a[198:199], v5 offset:25088
    s_waitcnt lgkmcnt(4)
    s_add_u32 m0, s67, 10240
    s_add_u32 s92, s66, 286720
    buffer_load_dwordx4 v2, s[32:35], s92 offen lds
    buffer_load_dwordx4 v9, s[32:35], s92 offen offset:1024 lds
    v_mfma_f32_16x16x32_bf16 v[68:71], a[200:203], v[180:183], v[68:71]
    ds_read_b64_tr_b16 a[200:201], v5 offset:28672
    v_max_f32 v38, 0, v38
    v_max_f32 v39, 0, v39
    v_mfma_f32_16x16x32_bf16 v[72:75], a[204:207], v[176:179], v[72:75]
    ds_read_b64_tr_b16 a[202:203], v5 offset:32256
    v_mul_f32 v36, v36, v36
    v_mul_f32 v37, v37, v37
    v_mfma_f32_16x16x32_bf16 v[76:79], a[204:207], v[180:183], v[76:79]
    ds_read_b64_tr_b16 a[204:205], v5 offset:35840
    v_mul_f32 v38, v38, v38
    v_mul_f32 v39, v39, v39
    v_mfma_f32_16x16x32_bf16 v[64:67], a[208:211], v[184:187], v[64:67]
    ds_read_b64_tr_b16 a[206:207], v5 offset:39424
    s_waitcnt vmcnt(13)
    ds_read_b64_tr_b16 a[160:161], v3 offset:12288
    ds_read_b64_tr_b16 a[162:163], v3 offset:13312
    ds_read_b64_tr_b16 a[164:165], v4 offset:12288
    ds_read_b64_tr_b16 a[166:167], v4 offset:13312
    v_mfma_f32_16x16x32_bf16 v[68:71], a[208:211], v[188:191], v[68:71]
    ds_read_b64_tr_b16 a[208:209], v5 offset:43008
    v_cvt_pk_bf16_f32 v244, v36, v37
    v_cvt_pk_bf16_f32 v245, v38, v39
    v_mfma_f32_16x16x32_bf16 v[72:75], a[212:215], v[184:187], v[72:75]
    ds_read_b64_tr_b16 a[210:211], v5 offset:46592
    v_fma_f32 v44, v44, v21, v100
    v_fma_f32 v45, v45, v21, v101
    v_mfma_f32_16x16x32_bf16 v[76:79], a[212:215], v[188:191], v[76:79]
    ds_read_b64_tr_b16 a[212:213], v6 offset:0
    v_fma_f32 v46, v46, v21, v102
    v_fma_f32 v47, v47, v21, v103
    v_mfma_f32_16x16x32_bf16 v[64:67], a[216:219], v[192:195], v[64:67]
    ds_read_b64_tr_b16 a[214:215], v6 offset:3584
    s_waitcnt lgkmcnt(4)
    buffer_load_dwordx4 v10, s[32:35], s92 offen offset:2048 lds
    buffer_load_dwordx4 v11, s[32:35], s92 offen offset:3072 lds
    v_mfma_f32_16x16x32_bf16 v[68:71], a[216:219], v[196:199], v[68:71]
    ds_read_b64_tr_b16 a[216:217], v6 offset:7168
    v_max_f32 v44, 0, v44
    v_max_f32 v45, 0, v45
    v_mfma_f32_16x16x32_bf16 v[72:75], a[220:223], v[192:195], v[72:75]
    ds_read_b64_tr_b16 a[218:219], v6 offset:10752
    v_max_f32 v46, 0, v46
    v_max_f32 v47, 0, v47
    v_mfma_f32_16x16x32_bf16 v[76:79], a[220:223], v[196:199], v[76:79]
    ds_read_b64_tr_b16 a[220:221], v6 offset:14336
    v_mul_f32 v44, v44, v44
    v_mul_f32 v45, v45, v45
    v_mfma_f32_16x16x32_bf16 v[64:67], a[224:227], v[200:203], v[64:67]
    ds_read_b64_tr_b16 a[222:223], v6 offset:17920
    v_mul_f32 v46, v46, v46
    v_mul_f32 v47, v47, v47
    v_mfma_f32_16x16x32_bf16 v[68:71], a[224:227], v[204:207], v[68:71]
    ds_read_b64_tr_b16 a[224:225], v6 offset:21504
    v_cvt_pk_bf16_f32 v246, v44, v45
    v_cvt_pk_bf16_f32 v247, v46, v47
    v_mfma_f32_16x16x32_bf16 v[72:75], a[228:231], v[200:203], v[72:75]
    ds_read_b64_tr_b16 a[226:227], v6 offset:25088
    s_cmp_eq_u32 s65, 0
    s_cbranch_scc1 L_slow_33
    s_add_u32 s61, s72, 14336
    buffer_store_dwordx4 v[244:247], v1, s[48:51], s61 offen
L_back_34:
    v_mfma_f32_16x16x32_bf16 v[76:79], a[228:231], v[204:207], v[76:79]
    ds_read_b64_tr_b16 a[228:229], v6 offset:28672
    v_fma_f32 v48, v48, v20, v104
    v_fma_f32 v49, v49, v20, v105
    v_mfma_f32_16x16x32_bf16 v[64:67], a[232:235], v[208:211], v[64:67]
    ds_read_b64_tr_b16 a[230:231], v6 offset:32256
    v_fma_f32 v50, v50, v20, v106
    v_fma_f32 v51, v51, v20, v107
    v_mfma_f32_16x16x32_bf16 v[68:71], a[232:235], v[212:215], v[68:71]
    ds_read_b64_tr_b16 a[232:233], v6 offset:35840
    v_max_f32 v48, 0, v48
    v_max_f32 v49, 0, v49
    v_mfma_f32_16x16x32_bf16 v[72:75], a[236:239], v[208:211], v[72:75]
    ds_read_b64_tr_b16 a[234:235], v6 offset:39424
    v_max_f32 v50, 0, v50
    v_max_f32 v51, 0, v51
    v_mfma_f32_16x16x32_bf16 v[76:79], a[236:239], v[212:215], v[76:79]
    ds_read_b64_tr_b16 a[236:237], v6 offset:43008
    v_mul_f32 v48, v48, v48
    v_mul_f32 v49, v49, v49
    v_mfma_f32_16x16x32_bf16 v[64:67], a[240:243], v[216:219], v[64:67]
    ds_read_b64_tr_b16 a[238:239], v6 offset:46592
    v_mul_f32 v50, v50, v50
    v_mul_f32 v51, v51, v51
    v_mfma_f32_16x16x32_bf16 v[68:71], a[240:243], v[220:223], v[68:71]
    v_cvt_pk_bf16_f32 v240, v48, v49
    v_cvt_pk_bf16_f32 v241, v50, v51
    v_mfma_f32_16x16x32_bf16 v[72:75], a[244:247], v[216:219], v[72:75]
    v_fma_f32 v56, v56, v20, v112
    v_fma_f32 v57, v57, v20, v113
    v_mfma_f32_16x16x32_bf16 v[76:79], a[244:247], v[220:223], v[76:79]
    v_fma_f32 v58, v58, v20, v114
    v_fma_f32 v59, v59, v20, v115
    v_mfma_f32_16x16x32_bf16 v[64:67], a[168:171], v[224:227], v[64:67]
    v_max_f32 v56, 0, v56
    v_max_f32 v57, 0, v57
    v_mfma_f32_16x16x32_bf16 v[68:71], a[168:171], v[228:231], v[68:71]
    v_max_f32 v58, 0, v58
    v_max_f32 v59, 0, v59
    v_mfma_f32_16x16x32_bf16 v[72:75], a[172:175], v[224:227], v[72:75]
    v_mul_f32 v56, v56, v56
    v_mul_f32 v57, v57, v57
    v_mfma_f32_16x16x32_bf16 v[76:79], a[172:175], v[228:231], v[76:79]
    v_mul_f32 v58, v58, v58
    v_mul_f32 v59, v59, v59
    v_mfma_f32_16x16x32_bf16 v[64:67], a[176:179], v[232:235], v[64:67]
    v_cvt_pk_bf16_f32 v242, v56, v57
    v_cvt_pk_bf16_f32 v243, v58, v59
    v_mfma_f32_16x16x32_bf16 v[68:71], a[176:179], v[236:239], v[68:71]
    s_cmp_eq_u32 s65, 0
    s_cbranch_scc1 L_slow_35
    s_add_u32 s61, s72, 1024
    buffer_store_dwordx4 v[240:243], v1, s[48:51], s61 offen
L_back_36:
    v_mfma_f32_16x16x32_bf16 v[72:75], a[180:183], v[232:235], v[72:75]
    v_fma_f32 v52, v52, v21, v108
    v_fma_f32 v53, v53, v21, v109
    v_mfma_f32_16x16x32_bf16 v[76:79], a[180:183], v[236:239], v[76:79]
    v_fma_f32 v54, v54, v21, v110
    v_fma_f32 v55, v55, v21, v111
    v_mfma_f32_16x16x32_bf16 v[80:83], a[184:187], v[128:131], v[80:83]
    v_max_f32 v52, 0, v52
    v_max_f32 v53, 0, v53
    v_mfma_f32_16x16x32_bf16 v[84:87], a[184:187], v[132:135], v[84:87]
    v_max_f32 v54, 0, v54
    v_max_f32 v55, 0, v55
    v_mfma_f32_16x16x32_bf16 v[80:83], a[188:191], v[136:139], v[80:83]
    v_mul_f32 v52, v52, v52
    v_mul_f32 v53, v53, v53
    v_mfma_f32_16x16x32_bf16 v[84:87], a[188:191], v[140:143], v[84:87]
    v_mul_f32 v54, v54, v54
    v_mul_f32 v55, v55, v55
    v_mfma_f32_16x16x32_bf16 v[80:83], a[192:195], v[144:147], v[80:83]
    v_cvt_pk_bf16_f32 v244, v52, v53
    v_cvt_pk_bf16_f32 v245, v54, v55
    v_mfma_f32_16x16x32_bf16 v[84:87], a[192:195], v[148:151], v[84:87]
    v_fma_f32 v60, v60, v21, v116
    v_fma_f32 v61, v61, v21, v117
    v_mfma_f32_16x16x32_bf16 v[80:83], a[196:199], v[152:155], v[80:83]
    v_fma_f32 v62, v62, v21, v118
    v_fma_f32 v63, v63, v21, v119
    v_mfma_f32_16x16x32_bf16 v[84:87], a[196:199], v[156:159], v[84:87]
    v_max_f32 v60, 0, v60
    v_max_f32 v61, 0, v61
    v_mfma_f32_16x16x32_bf16 v[80:83], a[200:203], v[160:163], v[80:83]
    v_max_f32 v62, 0, v62
    v_max_f32 v63, 0, v63
    v_mfma_f32_16x16x32_bf16 v[84:87], a[200:203], v[164:167], v[84:87]
    v_mul_f32 v60, v60, v60
    v_mul_f32 v61, v61, v61
    v_mfma_f32_16x16x32_bf16 v[80:83], a[204:207], v[168:171], v[80:83]
    v_mul_f32 v62, v62, v62
    v_mul_f32 v63, v63, v63
    v_mfma_f32_16x16x32_bf16 v[84:87], a[204:207], v[172:175], v[84:87]
    v_cvt_pk_bf16_f32 v246, v60, v61
    v_cvt_pk_bf16_f32 v247, v62, v63
    s_waitcnt lgkmcnt(14)
    v_mfma_f32_16x16x32_bf16 v[80:83], a[208:211], v[176:179], v[80:83]
    s_cmp_eq_u32 s65, 0
    s_cbranch_scc1 L_slow_37
    s_add_u32 s61, s72, 15360
    buffer_store_dwordx4 v[244:247], v1, s[48:51], s61 offen
L_back_38:
    v_mfma_f32_16x16x32_bf16 v[84:87], a[208:211], v[180:183], v[84:87]
    v_mul_f32 v64, v64, v20
    v_mul_f32 v65, v65, v20
    s_waitcnt lgkmcnt(12)
    v_mfma_f32_16x16x32_bf16 v[80:83], a[212:215], v[184:187], v[80:83]
    v_mul_f32 v66, v66, v20
    v_mul_f32 v67, v67, v20
    v_mfma_f32_16x16x32_bf16 v[84:87], a[212:215], v[188:191], v[84:87]
    v_max_f32 v64, 0, v64
    v_max_f32 v65, 0, v65
    s_waitcnt lgkmcnt(10)
    v_mfma_f32_16x16x32_bf16 v[80:83], a[216:219], v[192:195], v[80:83]
    v_max_f32 v66, 0, v66
    v_max_f32 v67, 0, v67
    v_mfma_f32_16x16x32_bf16 v[84:87], a[216:219], v[196:199], v[84:87]
    v_mul_f32 v64, v64, v64
    v_mul_f32 v65, v65, v65
    s_waitcnt lgkmcnt(8)
    v_mfma_f32_16x16x32_bf16 v[80:83], a[220:223], v[200:203], v[80:83]
    v_mul_f32 v66, v66, v66
    v_mul_f32 v67, v67, v67
    v_mfma_f32_16x16x32_bf16 v[84:87], a[220:223], v[204:207], v[84:87]
    v_cvt_pk_bf16_f32 v240, v64, v65
    v_cvt_pk_bf16_f32 v241, v66, v67
    s_waitcnt lgkmcnt(6)
    v_mfma_f32_16x16x32_bf16 v[80:83], a[224:227], v[208:211], v[80:83]
    v_mul_f32 v72, v72, v20
    v_mul_f32 v73, v73, v20
    v_mfma_f32_16x16x32_bf16 v[84:87], a[224:227], v[212:215], v[84:87]
    v_mul_f32 v74, v74, v20
    v_mul_f32 v75, v75, v20
L_ihw1_1:
    s_cbranch_execz L_ihw1_ret
    s_waitcnt lgkmcnt(4)
    v_mfma_f32_16x16x32_bf16 v[80:83], a[228:231], v[216:219], v[80:83]
    v_max_f32 v72, 0, v72
    v_max_f32 v73, 0, v73
    v_mfma_f32_16x16x32_bf16 v[84:87], a[228:231], v[220:223], v[84:87]
    v_max_f32 v74, 0, v74
    v_max_f32 v75, 0, v75
    s_waitcnt lgkmcnt(2)
    v_mfma_f32_16x16x32_bf16 v[80:83], a[232:235], v[224:227], v[80:83]
    v_mul_f32 v72, v72, v72
    v_mul_f32 v73, v73, v73
    v_mfma_f32_16x16x32_bf16 v[84:87], a[232:235], v[228:231], v[84:87]
    v_mul_f32 v74, v74, v74
    v_mul_f32 v75, v75, v75
    s_waitcnt lgkmcnt(0)
    v_mfma_f32_16x16x32_bf16 v[80:83], a[236:239], v[232:235], v[80:83]
    v_cvt_pk_bf16_f32 v242, v72, v73
    v_cvt_pk_bf16_f32 v243, v74, v75
    v_mfma_f32_16x16x32_bf16 v[84:87], a[236:239], v[236:239], v[84:87]
    s_cmp_eq_u32 s65, 0
    s_cbranch_scc1 L_slow_39
    s_add_u32 s61, s72, 2048
    buffer_store_dwordx4 v[240:243], v1, s[48:51], s61 offen
L_back_40:
    v_mul_f32 v68, v68, v21
    v_mul_f32 v69, v69, v21
    v_mul_f32 v70, v70, v21
    v_mul_f32 v71, v71, v21
    v_max_f32 v68, 0, v68
    v_max_f32 v69, 0, v69
    v_max_f32 v70, 0, v70
    v_max_f32 v71, 0, v71
    v_mul_f32 v68, v68, v68
    v_mul_f32 v69, v69, v69
    v_mul_f32 v70, v70, v70
    v_mul_f32 v71, v71, v71
    v_cvt_pk_bf16_f32 v244, v68, v69
    v_cvt_pk_bf16_f32 v245, v70, v71
    v_mul_f32 v76, v76, v21
    v_mul_f32 v77, v77, v21
    v_mul_f32 v78, v78, v21
    v_mul_f32 v79, v79, v21
    v_max_f32 v76, 0, v76
    v_max_f32 v77, 0, v77
    v_max_f32 v78, 0, v78
    v_max_f32 v79, 0, v79
    v_mul_f32 v76, v76, v76
    v_mul_f32 v77, v77, v77
    v_mul_f32 v78, v78, v78
    v_mul_f32 v79, v79, v79
    v_cvt_pk_bf16_f32 v246, v76, v77
    v_cvt_pk_bf16_f32 v247, v78, v79
    s_cmp_eq_u32 s65, 0
    s_cbranch_scc1 L_slow_41
    s_add_u32 s61, s72, 16384
    buffer_store_dwordx4 v[244:247], v1, s[48:51], s61 offen
L_back_42:
    s_waitcnt vmcnt(2)
    v_mov_b32 v31, 1
    s_cmp_eq_u32 s65, 0
    s_cbranch_scc1 L_slow_43
    s_mov_b64 exec, 1
    buffer_store_dword v31, off, s[48:51], s70 offset:0
    s_mov_b64 exec, -1
L_back_44:
    v_lshrrev_b32 v19, 5, v0
    v_bfe_u32 v28, v0, 4, 1
    v_and_b32 v29, 15, v0
    v_bfe_u32 v18, v0, 1, 2
    v_lshlrev_b32 v18, 4, v18
    v_and_b32 v14, 1, v0
    v_lshl_add_u32 v14, v14, 2, v18
    s_lshl_b32 s52, s3, 6
    s_lshl_b32 s7, s6, 3
    s_add_u32 s52, s52, s7
    s_add_u32 s52, s52, s63
    s_add_u32 s52, s52, 237568
    v_lshlrev_b32 v29, 4, v29
    v_lshl_add_u32 v29, v19, 8, v29
    s_movk_i32 s7, 14336
    v_mad_u32_u24 v17, v28, s7, v29
    v_mov_b32 v16, v17
    s_and_b32 s53, s3, 1
    s_lshl_b32 s54, s6, 1
    s_add_u32 s54, s54, s53
    s_mul_i32 s58, s54, 28672
    s_lshr_b32 s55, s3, 1
    s_lshl_b32 s7, s71, 1
    s_add_u32 s55, s55, s7
    s_lshl_b32 s7, s55, 10
    s_add_u32 s58, s58, s7
    s_add_u32 s58, s58, s63
    s_add_u32 s58, s58, 114688
    v_lshlrev_b32 v18, 3, v19
    s_lshl_b32 s53, s55, 6
    buffer_load_dwordx4 v[96:99], v17, s[48:51], s58 offen sc1
    buffer_load_dwordx4 v[100:103], v17, s[48:51], s58 offen offset:512 sc1
    buffer_load_dwordx2 v[104:105], v18, s[36:39], s53 offen
    buffer_load_dwordx2 v[106:107], v18, s[36:39], s53 offen offset:16
    buffer_load_dwordx2 v[108:109], v18, s[36:39], s53 offen offset:32
    buffer_load_dwordx2 v[110:111], v18, s[36:39], s53 offen offset:48
    s_mul_i32 s56, s54, 28672
    s_xor_b32 s7, s54, 1
    s_mul_i32 s57, s7, 28672
    s_min_u32 s7, s3, 1
    s_mul_i32 s7, s7, 147456
    s_add_u32 s7, s7, s63
    s_add_u32 s56, s56, s7
    s_add_u32 s57, s57, s7
    s_mul_i32 s7, s3, 114688
    s_add_u32 s56, s56, s7
    s_add_u32 s57, s57, s7
    buffer_load_dword v15, v14, s[48:51], s52 offen sc1
    v_mul_f32 v80, v80, v20
    v_mul_f32 v81, v81, v20
    v_mul_f32 v82, v82, v20
    v_mul_f32 v83, v83, v20
    v_max_f32 v80, 0, v80
    v_max_f32 v81, 0, v81
    v_max_f32 v82, 0, v82
    v_max_f32 v83, 0, v83
    v_mul_f32 v80, v80, v80
    v_mul_f32 v81, v81, v81
    v_mul_f32 v82, v82, v82
    v_mul_f32 v83, v83, v83
    v_cvt_pk_bf16_f32 v240, v80, v81
    v_cvt_pk_bf16_f32 v241, v82, v83
    s_cmp_eq_u32 s65, 0
    s_cbranch_scc1 L_slow_45
    s_add_u32 s61, s62, 0
    buffer_store_dwordx2 v[240:241], v1, s[48:51], s61 offen
L_back_46:
    v_mul_f32 v84, v84, v21
    v_mul_f32 v85, v85, v21
    v_mul_f32 v86, v86, v21
    v_mul_f32 v87, v87, v21
    v_max_f32 v84, 0, v84
    v_max_f32 v85, 0, v85
    v_max_f32 v86, 0, v86
    v_max_f32 v87, 0, v87
    v_mul_f32 v84, v84, v84
    v_mul_f32 v85, v85, v85
    v_mul_f32 v86, v86, v86
    v_mul_f32 v87, v87, v87
    v_cvt_pk_bf16_f32 v244, v84, v85
    v_cvt_pk_bf16_f32 v245, v86, v87
    s_cmp_eq_u32 s65, 0
    s_cbranch_scc1 L_slow_47
    s_add_u32 s61, s62, 14336
    buffer_store_dwordx2 v[244:245], v1, s[48:51], s61 offen
L_back_48:
    s_cmp_ge_u32 s5, 14
    s_cbranch_scc1 L_skip4
    s_waitcnt vmcnt(2)
    v_cmp_ne_u32 vcc, 1, v15
    s_cbranch_vccnz L_fl_49
L_flok_50:
    s_add_u32 s61, s56, 0
    buffer_load_dwordx4 v[112:115], v16, s[48:51], s61 offen sc1
    s_add_u32 s61, s57, 0
    buffer_load_dwordx4 v[116:119], v16, s[48:51], s61 offen sc1
    s_add_u32 s61, s56, 512
    buffer_load_dwordx4 v[120:123], v16, s[48:51], s61 offen sc1
    s_add_u32 s61, s57, 512
    buffer_load_dwordx4 v[124:127], v16, s[48:51], s61 offen sc1
    s_add_u32 s61, s56, 1024
    buffer_load_dwordx4 v[128:131], v16, s[48:51], s61 offen sc1
    s_add_u32 s61, s57, 1024
    buffer_load_dwordx4 v[132:135], v16, s[48:51], s61 offen sc1
    s_add_u32 s61, s56, 1536
    buffer_load_dwordx4 v[136:139], v16, s[48:51], s61 offen sc1
    s_add_u32 s61, s57, 1536
    buffer_load_dwordx4 v[140:143], v16, s[48:51], s61 offen sc1
    s_waitcnt vmcnt(8)
    v_mov_b32 v31, 1
    s_cmp_eq_u32 s65, 0
    s_cbranch_scc1 L_slow_51
    s_mov_b64 exec, 1
    buffer_store_dword v31, off, s[48:51], s70 offset:256
    s_mov_b64 exec, -1
L_back_52:
    v_max3_u32 v30, v96, v98, v100
    v_max_u32 v30, v102, v30
    v_cmp_eq_u32 vcc, -1, v30
    s_cbranch_vccnz L_retry_53
L_ok_54:
    v_lshlrev_b32 v32, 16, v96
    v_and_b32 v33, 0xffff0000, v96
    v_lshlrev_b32 v30, 16, v104
    v_and_b32 v31, 0xffff0000, v104
    v_add_f32 v32, v32, v30
    v_add_f32 v33, v33, v31
    s_add_u32 s61, s56, 4096
    buffer_load_dwordx4 v[144:147], v16, s[48:51], s61 offen sc1
    v_lshlrev_b32 v34, 16, v97
    v_and_b32 v35, 0xffff0000, v97
    v_lshlrev_b32 v30, 16, v105
    v_and_b32 v31, 0xffff0000, v105
L_ihw1_3:
    s_cbranch_execz L_ihw1_ret
    v_add_f32 v34, v34, v30
    v_add_f32 v35, v35, v31
    s_add_u32 s61, s57, 4096
    buffer_load_dwordx4 v[148:151], v16, s[48:51], s61 offen sc1
    v_lshlrev_b32 v40, 16, v98
    v_and_b32 v41, 0xffff0000, v98
    v_lshlrev_b32 v30, 16, v108
    v_and_b32 v31, 0xffff0000, v108
    v_add_f32 v40, v40, v30
    v_add_f32 v41, v41, v31
    s_add_u32 s61, s56, 4608
    buffer_load_dwordx4 v[152:155], v16, s[48:51], s61 offen sc1
    v_lshlrev_b32 v42, 16, v99
    v_and_b32 v43, 0xffff0000, v99
    v_lshlrev_b32 v30, 16, v109
    v_and_b32 v31, 0xffff0000, v109
    v_add_f32 v42, v42, v30
    v_add_f32 v43, v43, v31
    s_add_u32 s61, s57, 4608
    buffer_load_dwordx4 v[156:159], v16, s[48:51], s61 offen sc1
    v_lshlrev_b32 v36, 16, v100
    v_and_b32 v37, 0xffff0000, v100
    v_lshlrev_b32 v30, 16, v106
    v_and_b32 v31, 0xffff0000, v106
    v_add_f32 v36, v36, v30
    v_add_f32 v37, v37, v31
    s_add_u32 s61, s56, 5120
    buffer_load_dwordx4 v[160:163], v16, s[48:51], s61 offen sc1
    v_lshlrev_b32 v38, 16, v101
    v_and_b32 v39, 0xffff0000, v101
    v_lshlrev_b32 v30, 16, v107
    v_and_b32 v31, 0xffff0000, v107
    v_add_f32 v38, v38, v30
    v_add_f32 v39, v39, v31
    s_add_u32 s61, s57, 5120
    buffer_load_dwordx4 v[164:167], v16, s[48:51], s61 offen sc1
    v_lshlrev_b32 v44, 16, v102
    v_and_b32 v45, 0xffff0000, v102
    v_lshlrev_b32 v30, 16, v110
    v_and_b32 v31, 0xffff0000, v110
    v_add_f32 v44, v44, v30
    v_add_f32 v45, v45, v31
    s_add_u32 s61, s56, 5632
    buffer_load_dwordx4 v[168:171], v16, s[48:51], s61 offen sc1
    v_lshlrev_b32 v46, 16, v103
    v_and_b32 v47, 0xffff0000, v103
    v_lshlrev_b32 v30, 16, v111
    v_and_b32 v31, 0xffff0000, v111
    v_add_f32 v46, v46, v30
    v_add_f32 v47, v47, v31
    s_add_u32 s61, s57, 5632
    buffer_load_dwordx4 v[172:175], v16, s[48:51], s61 offen sc1
    s_waitcnt vmcnt(15)
    v_mfma_f32_32x32x16_bf16 v[32:47], a[0:3], v[112:115], v[32:47]
    s_add_u32 s61, s56, 7168
    buffer_load_dwordx4 v[176:179], v16, s[48:51], s61 offen sc1
    v_mfma_f32_32x32x16_bf16 v[48:63], a[0:3], v[116:119], 0
    s_add_u32 s61, s57, 7168
    buffer_load_dwordx4 v[180:183], v16, s[48:51], s61 offen sc1
    v_mfma_f32_32x32x16_bf16 v[64:79], a[4:7], v[112:115], 0
    v_mfma_f32_32x32x16_bf16 v[80:95], a[4:7], v[116:119], 0
    s_waitcnt vmcnt(15)
    v_mfma_f32_32x32x16_bf16 v[32:47], a[8:11], v[120:123], v[32:47]
    s_add_u32 s61, s56, 7680
    buffer_load_dwordx4 v[184:187], v16, s[48:51], s61 offen sc1
    v_mfma_f32_32x32x16_bf16 v[48:63], a[8:11], v[124:127], v[48:63]
    s_add_u32 s61, s57, 7680
    buffer_load_dwordx4 v[188:191], v16, s[48:51], s61 offen sc1
    v_mfma_f32_32x32x16_bf16 v[64:79], a[12:15], v[120:123], v[64:79]
    v_mfma_f32_32x32x16_bf16 v[80:95], a[12:15], v[124:127], v[80:95]
    s_waitcnt vmcnt(15)
    v_mfma_f32_32x32x16_bf16 v[32:47], a[16:19], v[128:131], v[32:47]
    s_add_u32 s61, s56, 8192
    buffer_load_dwordx4 v[192:195], v16, s[48:51], s61 offen sc1
    v_mfma_f32_32x32x16_bf16 v[48:63], a[16:19], v[132:135], v[48:63]
    s_add_u32 s61, s57, 8192
    buffer_load_dwordx4 v[196:199], v16, s[48:51], s61 offen sc1
    v_mfma_f32_32x32x16_bf16 v[64:79], a[20:23], v[128:131], v[64:79]
    v_mfma_f32_32x32x16_bf16 v[80:95], a[20:23], v[132:135], v[80:95]
    s_waitcnt vmcnt(15)
    v_mfma_f32_32x32x16_bf16 v[32:47], a[24:27], v[136:139], v[32:47]
    s_add_u32 s61, s56, 8704
    buffer_load_dwordx4 v[200:203], v16, s[48:51], s61 offen sc1
    v_mfma_f32_32x32x16_bf16 v[48:63], a[24:27], v[140:143], v[48:63]
    s_add_u32 s61, s57, 8704
    buffer_load_dwordx4 v[204:207], v16, s[48:51], s61 offen sc1
    v_mfma_f32_32x32x16_bf16 v[64:79], a[28:31], v[136:139], v[64:79]
    v_mfma_f32_32x32x16_bf16 v[80:95], a[28:31], v[140:143], v[80:95]
    s_waitcnt vmcnt(14)
    v_mfma_f32_32x32x16_bf16 v[32:47], a[32:35], v[144:147], v[32:47]
    s_add_u32 s61, s56, 11264
    buffer_load_dwordx4 v[208:211], v16, s[48:51], s61 offen sc1
    ds_read_b64_tr_b16 a[168:169], v3 offset:0
    v_mfma_f32_32x32x16_bf16 v[48:63], a[32:35], v[148:151], v[48:63]
    s_add_u32 s61, s57, 11264
    buffer_load_dwordx4 v[212:215], v16, s[48:51], s61 offen sc1
    ds_read_b64_tr_b16 a[170:171], v3 offset:1024
    v_mfma_f32_32x32x16_bf16 v[64:79], a[36:39], v[144:147], v[64:79]
    ds_read_b64_tr_b16 a[172:173], v4 offset:0
    v_mfma_f32_32x32x16_bf16 v[80:95], a[36:39], v[148:151], v[80:95]
    ds_read_b64_tr_b16 a[174:175], v4 offset:1024
    s_waitcnt vmcnt(14)
    v_mfma_f32_32x32x16_bf16 v[32:47], a[40:43], v[152:155], v[32:47]
    s_add_u32 s61, s56, 11776
    buffer_load_dwordx4 v[216:219], v16, s[48:51], s61 offen sc1
    ds_read_b64_tr_b16 a[176:177], v3 offset:2048
    v_mfma_f32_32x32x16_bf16 v[48:63], a[40:43], v[156:159], v[48:63]
    s_add_u32 s61, s57, 11776
    buffer_load_dwordx4 v[220:223], v16, s[48:51], s61 offen sc1
    ds_read_b64_tr_b16 a[178:179], v3 offset:3072
    v_mfma_f32_32x32x16_bf16 v[64:79], a[44:47], v[152:155], v[64:79]
    ds_read_b64_tr_b16 a[180:181], v4 offset:2048
    v_mfma_f32_32x32x16_bf16 v[80:95], a[44:47], v[156:159], v[80:95]
    ds_read_b64_tr_b16 a[182:183], v4 offset:3072
    buffer_load_dword v15, v14, s[48:51], s52 offen offset:256 sc1
    s_waitcnt vmcnt(15)
    v_mfma_f32_32x32x16_bf16 v[32:47], a[48:51], v[160:163], v[32:47]
    s_add_u32 s61, s56, 12288
    buffer_load_dwordx4 v[224:227], v16, s[48:51], s61 offen sc1
    ds_read_b64_tr_b16 a[184:185], v3 offset:4096
    v_mfma_f32_32x32x16_bf16 v[48:63], a[48:51], v[164:167], v[48:63]
    s_add_u32 s61, s57, 12288
    buffer_load_dwordx4 v[228:231], v16, s[48:51], s61 offen sc1
    ds_read_b64_tr_b16 a[186:187], v3 offset:5120
    v_mfma_f32_32x32x16_bf16 v[64:79], a[52:55], v[160:163], v[64:79]
    ds_read_b64_tr_b16 a[188:189], v4 offset:4096
    v_mfma_f32_32x32x16_bf16 v[80:95], a[52:55], v[164:167], v[80:95]
    ds_read_b64_tr_b16 a[190:191], v4 offset:5120
    s_waitcnt vmcnt(15)
    v_mfma_f32_32x32x16_bf16 v[32:47], a[56:59], v[168:171], v[32:47]
    s_add_u32 s61, s56, 12800
    buffer_load_dwordx4 v[232:235], v16, s[48:51], s61 offen sc1
    ds_read_b64_tr_b16 a[192:193], v3 offset:6144
    v_mfma_f32_32x32x16_bf16 v[48:63], a[56:59], v[172:175], v[48:63]
    s_add_u32 s61, s57, 12800
    buffer_load_dwordx4 v[236:239], v16, s[48:51], s61 offen sc1
    ds_read_b64_tr_b16 a[194:195], v3 offset:7168
    v_mfma_f32_32x32x16_bf16 v[64:79], a[60:63], v[168:171], v[64:79]
    ds_read_b64_tr_b16 a[196:197], v4 offset:6144
    v_mfma_f32_32x32x16_bf16 v[80:95], a[60:63], v[172:175], v[80:95]
    ds_read_b64_tr_b16 a[198:199], v4 offset:7168
    s_waitcnt vmcnt(15)
    v_mfma_f32_32x32x16_bf16 v[32:47], a[64:67], v[176:179], v[32:47]
    ds_read_b64_tr_b16 a[200:201], v3 offset:8192
    v_mfma_f32_32x32x16_bf16 v[48:63], a[64:67], v[180:183], v[48:63]
    ds_read_b64_tr_b16 a[202:203], v3 offset:9216
    v_mfma_f32_32x32x16_bf16 v[64:79], a[68:71], v[176:179], v[64:79]
    ds_read_b64_tr_b16 a[204:205], v4 offset:8192
    v_mfma_f32_32x32x16_bf16 v[80:95], a[68:71], v[180:183], v[80:95]
    ds_read_b64_tr_b16 a[206:207], v4 offset:9216
    s_waitcnt vmcnt(13)
    v_mfma_f32_32x32x16_bf16 v[32:47], a[72:75], v[184:187], v[32:47]
    ds_read_b64_tr_b16 a[208:209], v3 offset:10240
    v_mfma_f32_32x32x16_bf16 v[48:63], a[72:75], v[188:191], v[48:63]
    ds_read_b64_tr_b16 a[210:211], v3 offset:11264
    v_mfma_f32_32x32x16_bf16 v[64:79], a[76:79], v[184:187], v[64:79]
    ds_read_b64_tr_b16 a[212:213], v4 offset:10240
    v_mfma_f32_32x32x16_bf16 v[80:95], a[76:79], v[188:191], v[80:95]
    ds_read_b64_tr_b16 a[214:215], v4 offset:11264
    s_waitcnt vmcnt(4)
    v_cmp_ne_u32 vcc, 1, v15
    s_cbranch_vccnz L_fl_55
L_flok_56:
    v_mfma_f32_32x32x16_bf16 v[32:47], a[80:83], v[192:195], v[32:47]
    s_add_u32 s61, s56, 2048
    buffer_load_dwordx4 v[112:115], v16, s[48:51], s61 offen sc1
    ds_read_b64_tr_b16 a[216:217], v3 offset:12288
    v_mfma_f32_32x32x16_bf16 v[48:63], a[80:83], v[196:199], v[48:63]
    s_add_u32 s61, s57, 2048
    buffer_load_dwordx4 v[116:119], v16, s[48:51], s61 offen sc1
    ds_read_b64_tr_b16 a[218:219], v3 offset:13312
    v_mfma_f32_32x32x16_bf16 v[64:79], a[84:87], v[192:195], v[64:79]
    s_add_u32 s61, s56, 2560
    buffer_load_dwordx4 v[120:123], v16, s[48:51], s61 offen sc1
    ds_read_b64_tr_b16 a[220:221], v4 offset:12288
    v_mfma_f32_32x32x16_bf16 v[80:95], a[84:87], v[196:199], v[80:95]
    s_add_u32 s61, s57, 2560
    buffer_load_dwordx4 v[124:127], v16, s[48:51], s61 offen sc1
    ds_read_b64_tr_b16 a[222:223], v4 offset:13312
    v_mfma_f32_32x32x16_bf16 v[32:47], a[88:91], v[200:203], v[32:47]
    s_add_u32 s61, s56, 6144
    buffer_load_dwordx4 v[128:131], v16, s[48:51], s61 offen sc1
    v_mfma_f32_32x32x16_bf16 v[48:63], a[88:91], v[204:207], v[48:63]
    s_add_u32 s61, s57, 6144
    buffer_load_dwordx4 v[132:135], v16, s[48:51], s61 offen sc1
    v_mfma_f32_32x32x16_bf16 v[64:79], a[92:95], v[200:203], v[64:79]
    s_add_u32 s61, s56, 6656
    buffer_load_dwordx4 v[136:139], v16, s[48:51], s61 offen sc1
    v_mfma_f32_32x32x16_bf16 v[80:95], a[92:95], v[204:207], v[80:95]
    s_add_u32 s61, s57, 6656
    buffer_load_dwordx4 v[140:143], v16, s[48:51], s61 offen sc1
    v_mfma_f32_32x32x16_bf16 v[32:47], a[96:99], v[208:211], v[32:47]
    s_add_u32 s61, s56, 9216
    buffer_load_dwordx4 v[144:147], v16, s[48:51], s61 offen sc1
    v_mfma_f32_32x32x16_bf16 v[48:63], a[96:99], v[212:215], v[48:63]
    s_add_u32 s61, s57, 9216
    buffer_load_dwordx4 v[148:151], v16, s[48:51], s61 offen sc1
    v_mfma_f32_32x32x16_bf16 v[64:79], a[100:103], v[208:211], v[64:79]
    s_add_u32 s61, s56, 9728
    buffer_load_dwordx4 v[152:155], v16, s[48:51], s61 offen sc1
    v_mfma_f32_32x32x16_bf16 v[80:95], a[100:103], v[212:215], v[80:95]
    s_add_u32 s61, s57, 9728
    buffer_load_dwordx4 v[156:159], v16, s[48:51], s61 offen sc1
    v_mfma_f32_32x32x16_bf16 v[32:47], a[104:107], v[216:219], v[32:47]
    s_add_u32 s61, s56, 13312
    buffer_load_dwordx4 v[160:163], v16, s[48:51], s61 offen sc1
    v_mfma_f32_32x32x16_bf16 v[48:63], a[104:107], v[220:223], v[48:63]
    s_add_u32 s61, s57, 13312
    buffer_load_dwordx4 v[164:167], v16, s[48:51], s61 offen sc1
    v_mfma_f32_32x32x16_bf16 v[64:79], a[108:111], v[216:219], v[64:79]
    v_mfma_f32_32x32x16_bf16 v[80:95], a[108:111], v[220:223], v[80:95]
    s_waitcnt vmcnt(16)
    v_mfma_f32_32x32x16_bf16 v[32:47], a[112:115], v[224:227], v[32:47]
    s_add_u32 s61, s56, 13824
    buffer_load_dwordx4 v[168:171], v16, s[48:51], s61 offen sc1
    v_mfma_f32_32x32x16_bf16 v[48:63], a[112:115], v[228:231], v[48:63]
    s_add_u32 s61, s57, 13824
    buffer_load_dwordx4 v[172:175], v16, s[48:51], s61 offen sc1
    v_mfma_f32_32x32x16_bf16 v[64:79], a[116:119], v[224:227], v[64:79]
    v_mfma_f32_32x32x16_bf16 v[80:95], a[116:119], v[228:231], v[80:95]
    s_waitcnt vmcnt(16)
    v_mfma_f32_32x32x16_bf16 v[32:47], a[120:123], v[232:235], v[32:47]
    s_add_u32 s61, s56, 3072
    buffer_load_dwordx4 v[176:179], v16, s[48:51], s61 offen sc1
    v_mfma_f32_32x32x16_bf16 v[48:63], a[120:123], v[236:239], v[48:63]
    s_add_u32 s61, s57, 3072
    buffer_load_dwordx4 v[180:183], v16, s[48:51], s61 offen sc1
    v_mfma_f32_32x32x16_bf16 v[64:79], a[124:127], v[232:235], v[64:79]
    v_mfma_f32_32x32x16_bf16 v[80:95], a[124:127], v[236:239], v[80:95]
    s_waitcnt vmcnt(16)
    v_mfma_f32_32x32x16_bf16 v[32:47], a[128:131], v[112:115], v[32:47]
    s_add_u32 s61, s56, 3584
    buffer_load_dwordx4 v[184:187], v16, s[48:51], s61 offen sc1
    v_mfma_f32_32x32x16_bf16 v[48:63], a[128:131], v[116:119], v[48:63]
    s_add_u32 s61, s57, 3584
    buffer_load_dwordx4 v[188:191], v16, s[48:51], s61 offen sc1
    v_mfma_f32_32x32x16_bf16 v[64:79], a[132:135], v[112:115], v[64:79]
    v_mfma_f32_32x32x16_bf16 v[80:95], a[132:135], v[116:119], v[80:95]
    s_mul_i32 s62, s4, 720896
    s_lshl_b32 s7, s5, 2
    s_add_u32 s7, s7, s3
    s_lshl_b32 s7, s7, 2
    s_add_u32 s62, s62, s7
    s_add_u32 s62, s62, 2335232
    v_mov_b32 v31, 1
    s_mov_b64 exec, 1
    buffer_store_dword v31, off, s[48:51], s62
    s_mov_b64 exec, -1
    s_waitcnt vmcnt(17)
    v_mfma_f32_32x32x16_bf16 v[32:47], a[136:139], v[120:123], v[32:47]
    s_add_u32 s61, s56, 10240
    buffer_load_dwordx4 v[192:195], v16, s[48:51], s61 offen sc1
    v_mfma_f32_32x32x16_bf16 v[48:63], a[136:139], v[124:127], v[48:63]
    s_add_u32 s61, s57, 10240
    buffer_load_dwordx4 v[196:199], v16, s[48:51], s61 offen sc1
    v_mfma_f32_32x32x16_bf16 v[64:79], a[140:143], v[120:123], v[64:79]
    v_mfma_f32_32x32x16_bf16 v[80:95], a[140:143], v[124:127], v[80:95]
    s_waitcnt vmcnt(17)
    v_mfma_f32_32x32x16_bf16 v[32:47], a[144:147], v[128:131], v[32:47]
    s_add_u32 s61, s56, 10752
    buffer_load_dwordx4 v[200:203], v16, s[48:51], s61 offen sc1
    v_mfma_f32_32x32x16_bf16 v[48:63], a[144:147], v[132:135], v[48:63]
    s_add_u32 s61, s57, 10752
    buffer_load_dwordx4 v[204:207], v16, s[48:51], s61 offen sc1
    v_mfma_f32_32x32x16_bf16 v[64:79], a[148:151], v[128:131], v[64:79]
    v_mfma_f32_32x32x16_bf16 v[80:95], a[148:151], v[132:135], v[80:95]
    s_waitcnt vmcnt(17)
    v_mfma_f32_32x32x16_bf16 v[32:47], a[152:155], v[136:139], v[32:47]
    v_mfma_f32_32x32x16_bf16 v[48:63], a[152:155], v[140:143], v[48:63]
    v_mfma_f32_32x32x16_bf16 v[64:79], a[156:159], v[136:139], v[64:79]
    v_mfma_f32_32x32x16_bf16 v[80:95], a[156:159], v[140:143], v[80:95]
    s_barrier
    s_waitcnt vmcnt(15)
    v_mfma_f32_32x32x16_bf16 v[32:47], a[160:163], v[144:147], v[32:47]
    v_mfma_f32_32x32x16_bf16 v[48:63], a[160:163], v[148:151], v[48:63]
    v_mfma_f32_32x32x16_bf16 v[64:79], a[164:167], v[144:147], v[64:79]
    v_mfma_f32_32x32x16_bf16 v[80:95], a[164:167], v[148:151], v[80:95]
    s_waitcnt vmcnt(13)
    s_waitcnt lgkmcnt(0)
    v_mfma_f32_32x32x16_bf16 v[32:47], a[168:171], v[152:155], v[32:47]
    v_mfma_f32_32x32x16_bf16 v[48:63], a[168:171], v[156:159], v[48:63]
    v_mfma_f32_32x32x16_bf16 v[64:79], a[172:175], v[152:155], v[64:79]
    v_mfma_f32_32x32x16_bf16 v[80:95], a[172:175], v[156:159], v[80:95]
    s_waitcnt vmcnt(11)
    v_mfma_f32_32x32x16_bf16 v[32:47], a[176:179], v[160:163], v[32:47]
    v_mfma_f32_32x32x16_bf16 v[48:63], a[176:179], v[164:167], v[48:63]
    v_mfma_f32_32x32x16_bf16 v[64:79], a[180:183], v[160:163], v[64:79]
    v_mfma_f32_32x32x16_bf16 v[80:95], a[180:183], v[164:167], v[80:95]
    s_waitcnt vmcnt(9)
    v_mfma_f32_32x32x16_bf16 v[32:47], a[184:187], v[168:171], v[32:47]
    v_mfma_f32_32x32x16_bf16 v[48:63], a[184:187], v[172:175], v[48:63]
    v_mfma_f32_32x32x16_bf16 v[64:79], a[188:191], v[168:171], v[64:79]
    v_mfma_f32_32x32x16_bf16 v[80:95], a[188:191], v[172:175], v[80:95]
    s_waitcnt vmcnt(7)
    v_mfma_f32_32x32x16_bf16 v[32:47], a[192:195], v[176:179], v[32:47]
    v_mfma_f32_32x32x16_bf16 v[48:63], a[192:195], v[180:183], v[48:63]
    v_mfma_f32_32x32x16_bf16 v[64:79], a[196:199], v[176:179], v[64:79]
    v_mfma_f32_32x32x16_bf16 v[80:95], a[196:199], v[180:183], v[80:95]
    s_waitcnt vmcnt(5)
    v_mfma_f32_32x32x16_bf16 v[32:47], a[200:203], v[184:187], v[32:47]
    v_mfma_f32_32x32x16_bf16 v[48:63], a[200:203], v[188:191], v[48:63]
    v_mfma_f32_32x32x16_bf16 v[64:79], a[204:207], v[184:187], v[64:79]
    v_mfma_f32_32x32x16_bf16 v[80:95], a[204:207], v[188:191], v[80:95]
    s_waitcnt vmcnt(2)
    v_mfma_f32_32x32x16_bf16 v[32:47], a[208:211], v[192:195], v[32:47]
    v_mfma_f32_32x32x16_bf16 v[48:63], a[208:211], v[196:199], v[48:63]
    v_mfma_f32_32x32x16_bf16 v[64:79], a[212:215], v[192:195], v[64:79]
    v_mfma_f32_32x32x16_bf16 v[80:95], a[212:215], v[196:199], v[80:95]
    s_waitcnt vmcnt(0)
    v_mfma_f32_32x32x16_bf16 v[32:47], a[216:219], v[200:203], v[32:47]
    v_mfma_f32_32x32x16_bf16 v[48:63], a[216:219], v[204:207], v[48:63]
    v_mfma_f32_32x32x16_bf16 v[64:79], a[220:223], v[200:203], v[64:79]
    v_mfma_f32_32x32x16_bf16 v[80:95], a[220:223], v[204:207], v[80:95]
    s_xor_b32 s7, s3, 1
    s_mul_i32 s7, s7, 12288
    s_add_u32 s7, s7, 58368
    v_add_u32 v31, s7, v1
    s_nop 5
    ds_write_b128 v31, v[48:51] offset:0
    ds_write_b128 v31, v[52:55] offset:1024
    ds_write_b128 v31, v[56:59] offset:2048
    ds_write_b128 v31, v[60:63] offset:3072
    s_xor_b32 s7, s3, 2
    s_mul_i32 s7, s7, 12288
    s_add_u32 s7, s7, 62464
    v_add_u32 v30, s7, v1
    ds_write_b128 v30, v[64:67] offset:0
    ds_write_b128 v30, v[68:71] offset:1024
    ds_write_b128 v30, v[72:75] offset:2048
    ds_write_b128 v30, v[76:79] offset:3072
    s_xor_b32 s7, s3, 3
    s_mul_i32 s7, s7, 12288
    s_add_u32 s7, s7, 66560
    v_add_u32 v31, s7, v1
    ds_write_b128 v31, v[80:83] offset:0
    ds_write_b128 v31, v[84:87] offset:1024
    ds_write_b128 v31, v[88:91] offset:2048
    ds_write_b128 v31, v[92:95] offset:3072
    s_mul_i32 s7, s3, 12288
    s_add_u32 s7, s7, 58368
    v_add_u32 v14, s7, v1
    v_and_b32 v17, 31, v0
    v_mul_u32_u24 v17, 896, v17
    v_lshl_add_u32 v17, v19, 4, v17
    s_lshl_b32 s7, s4, 2
    s_add_u32 s7, s7, s54
    s_mul_i32 s61, s7, 28672
    s_lshl_b32 s7, s55, 6
    s_add_u32 s61, s61, s7
    s_waitcnt lgkmcnt(0)
    s_barrier
    ds_read_b128 v[48:51], v14 offset:0
    ds_read_b128 v[52:55], v14 offset:1024
    ds_read_b128 v[56:59], v14 offset:2048
    ds_read_b128 v[60:63], v14 offset:3072
    ds_read_b128 v[64:67], v14 offset:4096
    ds_read_b128 v[68:71], v14 offset:5120
    ds_read_b128 v[72:75], v14 offset:6144
    ds_read_b128 v[76:79], v14 offset:7168
    ds_read_b128 v[80:83], v14 offset:8192
    ds_read_b128 v[84:87], v14 offset:9216
    ds_read_b128 v[88:91], v14 offset:10240
    ds_read_b128 v[92:95], v14 offset:11264
    s_waitcnt lgkmcnt(11)
    v_add_f32 v32, v32, v48
    v_add_f32 v33, v33, v49
    v_add_f32 v34, v34, v50
    v_add_f32 v35, v35, v51
    s_waitcnt lgkmcnt(10)
    v_add_f32 v36, v36, v52
    v_add_f32 v37, v37, v53
    v_add_f32 v38, v38, v54
    v_add_f32 v39, v39, v55
    s_waitcnt lgkmcnt(9)
    v_add_f32 v40, v40, v56
    v_add_f32 v41, v41, v57
    v_add_f32 v42, v42, v58
    v_add_f32 v43, v43, v59
    s_waitcnt lgkmcnt(8)
    v_add_f32 v44, v44, v60
    v_add_f32 v45, v45, v61
    v_add_f32 v46, v46, v62
    v_add_f32 v47, v47, v63
    s_waitcnt lgkmcnt(7)
    v_add_f32 v32, v32, v64
    v_add_f32 v33, v33, v65
    v_add_f32 v34, v34, v66
    v_add_f32 v35, v35, v67
    s_waitcnt lgkmcnt(6)
    v_add_f32 v36, v36, v68
    v_add_f32 v37, v37, v69
    v_add_f32 v38, v38, v70
    v_add_f32 v39, v39, v71
    s_waitcnt lgkmcnt(5)
    v_add_f32 v40, v40, v72
    v_add_f32 v41, v41, v73
    v_add_f32 v42, v42, v74
    v_add_f32 v43, v43, v75
    s_waitcnt lgkmcnt(4)
    v_add_f32 v44, v44, v76
    v_add_f32 v45, v45, v77
    v_add_f32 v46, v46, v78
    v_add_f32 v47, v47, v79
    s_waitcnt lgkmcnt(3)
    v_add_f32 v32, v32, v80
    v_add_f32 v33, v33, v81
    v_add_f32 v34, v34, v82
    v_add_f32 v35, v35, v83
    s_waitcnt lgkmcnt(2)
    v_add_f32 v36, v36, v84
    v_add_f32 v37, v37, v85
    v_add_f32 v38, v38, v86
    v_add_f32 v39, v39, v87
    s_waitcnt lgkmcnt(1)
    v_add_f32 v40, v40, v88
    v_add_f32 v41, v41, v89
    v_add_f32 v42, v42, v90
    v_add_f32 v43, v43, v91
    s_waitcnt lgkmcnt(0)
    v_add_f32 v44, v44, v92
    v_add_f32 v45, v45, v93
    v_add_f32 v46, v46, v94
    v_add_f32 v47, v47, v95
    v_cvt_pk_bf16_f32 v96, v32, v33
    v_cvt_pk_bf16_f32 v97, v34, v35
    v_cvt_pk_bf16_f32 v98, v36, v37
    v_cvt_pk_bf16_f32 v99, v38, v39
    v_cvt_pk_bf16_f32 v100, v40, v41
    v_cvt_pk_bf16_f32 v101, v42, v43
    v_cvt_pk_bf16_f32 v102, v44, v45
    v_cvt_pk_bf16_f32 v103, v46, v47
    v_permlane32_swap_b32 v96, v98
    v_permlane32_swap_b32 v97, v99
    v_permlane32_swap_b32 v100, v102
    v_permlane32_swap_b32 v101, v103
    buffer_store_dwordx4 v[96:99], v17, s[40:43], s61 offen
    buffer_store_dwordx4 v[100:103], v17, s[40:43], s61 offen offset:32
    s_nop 1
L_fin:
L_end:
    s_endpgm
L_non_1:
    s_nop 15
    s_nop 7
    s_mov_b32 s69, 16384
L_non_1l:
    buffer_load_dwordx2 v[250:251], off, s[44:47], 0 sc1
    s_waitcnt vmcnt(0)
    v_cmp_eq_u32 vcc, 0, v251
    s_sub_u32 s69, s69, 1
    s_nop 3
    s_cbranch_scc1 L_non_1x
    s_cbranch_vccnz L_non_1l
L_non_1x:
    s_nop 7
    s_branch L_nonok_2
L_kx_3:
    s_nop 15
    s_nop 7
    s_mov_b32 s69, 16384
L_kx_3l:
    buffer_load_dwordx4 v[128:131], v5, s[48:51], s52 offen sc1
    buffer_load_dwordx4 v[132:135], v5, s[48:51], s53 offen sc1
    s_waitcnt vmcnt(0)
    v_perm_b32 v136, v129, v128, s61
    v_perm_b32 v137, v131, v130, s62
    v_perm_b32 v138, v133, v132, s61
    v_perm_b32 v139, v135, v134, s62
    v_or_b32 v136, v136, v137
    v_or_b32 v138, v138, v139
    v_xor_b32 v136, s100, v136
L_ihw1_2:
    s_cbranch_execz L_ihw1_ret
    v_xor_b32 v138, s100, v138
    v_or_b32 v136, v136, v138
    v_cmp_ne_u32 vcc, 0, v136
    s_sub_u32 s69, s69, 1
    s_nop 3
    s_cbranch_scc1 L_kx_3x
    s_cbranch_vccnz L_kx_3l
L_kx_3x:
    s_nop 7
    s_branch L_kxok_4
L_rdy_5:
    s_nop 15
    s_nop 7
    s_mov_b32 s69, 16384
L_rdy_5l:
    buffer_load_dwordx2 v[250:251], v249, s[48:51], 0 offen sc1
    s_waitcnt vmcnt(0)
    v_and_b32 v30, -16, v251
    v_xor_b32 v30, s101, v30
    v_xor_b32 v31, s100, v250
    v_or_b32 v30, v30, v31
    v_cmp_ne_u32 vcc, 0, v30
    s_and_b32 vcc_lo, vcc_lo, -1
    s_mov_b32 vcc_hi, 0
    s_sub_u32 s69, s69, 1
    s_nop 1
    s_cbranch_scc1 L_rdy_5x
    s_cbranch_vccnz L_rdy_5l
L_rdy_5x:
    s_nop 7
    s_branch L_rdyok_6
L_split:
    s_nop 15
    s_nop 7
    s_add_u32 s63, s63, 16777216
    s_add_u32 s61, s96, 16777216
    v_mov_b32 v252, -1
    v_mov_b32 v253, -1
    v_mov_b32 v254, -1
    v_mov_b32 v255, -1
    buffer_store_dwordx4 v[252:255], v1, s[48:51], s61 offen sc1
    buffer_store_dwordx4 v[252:255], v1, s[48:51], s61 offen offset:1024 sc1
    buffer_store_dwordx4 v[252:255], v1, s[48:51], s61 offen offset:2048 sc1
    buffer_store_dwordx4 v[252:255], v1, s[48:51], s61 offen offset:3072 sc1
    s_waitcnt vmcnt(0)
    s_barrier
    s_cmp_lg_u32 s3, 0
    s_cbranch_scc1 L_splitw
    v_mov_b32 v250, s100
    v_mov_b32 v251, s101
    s_lshl_b32 s61, s4, 4
    s_add_u32 s61, s61, s5
    s_lshl_b32 s61, s61, 3
    s_add_u32 s61, s61, 13631488
    s_mov_b64 exec, 1
    buffer_store_dwordx2 v[250:251], off, s[48:51], s61 offset:2048 sc1
    s_mov_b64 exec, -1
    s_waitcnt vmcnt(0)
L_splitw:
    s_mov_b32 s69, 16384
L_splitl:
    buffer_load_dwordx2 v[250:251], v249, s[48:51], 0 offen offset:2048 sc1
    s_waitcnt vmcnt(0)
    v_and_b32 v30, -16, v251
    v_xor_b32 v30, s101, v30
    v_xor_b32 v31, s100, v250
    v_or_b32 v30, v30, v31
    v_cmp_ne_u32 vcc, 0, v30
    s_and_b32 vcc_lo, vcc_lo, 0xffff
    s_mov_b32 vcc_hi, 0
    s_sub_u32 s69, s69, 1
    s_nop 1
    s_cbranch_scc1 L_splitx
    s_cbranch_vccnz L_splitl
L_splitx:
    s_nop 7
    s_branch L_splitb
L_retry_7:
    s_nop 15
    s_nop 7
    s_mov_b32 s69, 16384
L_retry_7l:
    buffer_load_dwordx4 v[144:147], v1, s[48:51], s53 offen sc1
    buffer_load_dwordx4 v[148:151], v1, s[48:51], s53 offen offset:1024 sc1
    buffer_load_dwordx4 v[152:155], v1, s[48:51], s53 offen offset:2048 sc1
    buffer_load_dwordx4 v[156:159], v1, s[48:51], s53 offen offset:3072 sc1
    s_waitcnt vmcnt(0)
    v_max3_u32 v30, v144, v145, v146
    v_max3_u32 v30, v147, v148, v30
    v_max3_u32 v30, v149, v150, v30
    v_max3_u32 v30, v151, v152, v30
    v_max3_u32 v30, v153, v154, v30
    v_max3_u32 v30, v155, v156, v30
    v_max3_u32 v30, v157, v158, v30
    v_max_u32 v30, v159, v30
    v_cmp_eq_u32 vcc, -1, v30
    s_sub_u32 s69, s69, 1
    s_nop 3
    s_cbranch_scc1 L_retry_7x
    s_cbranch_vccnz L_retry_7l
L_retry_7x:
    s_nop 7
    s_branch L_ok_8
L_slow_9:
    s_nop 15
    s_nop 7
    buffer_store_dwordx2 v[96:97], v7, s[48:51], s52 offen sc1
    s_nop 1
    buffer_store_dwordx2 v[98:99], v8, s[48:51], s52 offen sc1
    s_nop 1
    buffer_store_dwordx2 v[100:101], v26, s[48:51], s52 offen sc1
    s_nop 1
    s_mov_b32 exec_hi, 0
    s_nop 1
    buffer_store_dwordx2 v[102:103], v27, s[48:51], s52 offen sc1
    s_nop 1
    s_mov_b32 exec_hi, -1
    s_nop 1
    s_nop 7
    s_branch L_back_10
L_retry_11:
    s_nop 15
    s_nop 7
    s_mov_b32 s69, 16384
L_retry_11l:
    buffer_load_dwordx4 v[32:35], v1, s[48:51], s53 offen sc1
    buffer_load_dwordx4 v[36:39], v1, s[48:51], s53 offen offset:1024 sc1
    buffer_load_dwordx4 v[40:43], v1, s[48:51], s53 offen offset:2048 sc1
    buffer_load_dwordx4 v[44:47], v1, s[48:51], s53 offen offset:3072 sc1
    buffer_load_dwordx4 v[48:51], v1, s[48:51], s54 offen sc1
    buffer_load_dwordx4 v[52:55], v1, s[48:51], s54 offen offset:1024 sc1
    buffer_load_dwordx4 v[56:59], v1, s[48:51], s54 offen offset:2048 sc1
    buffer_load_dwordx4 v[60:63], v1, s[48:51], s54 offen offset:3072 sc1
    s_waitcnt vmcnt(0)
    v_max3_u32 v30, v32, v34, v36
    v_max3_u32 v30, v38, v40, v30
    v_max3_u32 v30, v42, v44, v30
    v_max3_u32 v30, v46, v48, v30
    v_max_u32 v30, v50, v30
    v_cmp_eq_u32 vcc, -1, v30
    s_sub_u32 s69, s69, 1
    s_nop 3
    s_cbranch_scc1 L_retry_11x
    s_cbranch_vccnz L_retry_11l
L_retry_11x:
    s_nop 7
    s_branch L_ok_12
L_retry_13:
    s_nop 15
    s_nop 7
    s_mov_b32 s69, 16384
L_retry_13l:
    buffer_load_dwordx4 v[52:55], v1, s[48:51], s54 offen offset:1024 sc1
    buffer_load_dwordx4 v[56:59], v1, s[48:51], s54 offen offset:2048 sc1
    buffer_load_dwordx4 v[60:63], v1, s[48:51], s54 offen offset:3072 sc1
    buffer_load_dwordx4 v[64:67], v1, s[48:51], s55 offen sc1
    buffer_load_dwordx4 v[68:71], v1, s[48:51], s55 offen offset:1024 sc1
    buffer_load_dwordx4 v[72:75], v1, s[48:51], s55 offen offset:2048 sc1
    buffer_load_dwordx4 v[76:79], v1, s[48:51], s55 offen offset:3072 sc1
    buffer_load_dwordx4 v[80:83], v1, s[48:51], s72 offen sc1
    s_waitcnt vmcnt(0)
    v_max3_u32 v30, v52, v54, v56
    v_max3_u32 v30, v58, v60, v30
    v_max3_u32 v30, v62, v64, v30
    v_max3_u32 v30, v66, v68, v30
    v_max_u32 v30, v70, v30
    v_cmp_eq_u32 vcc, -1, v30
    s_sub_u32 s69, s69, 1
    s_nop 3
    s_cbranch_scc1 L_retry_13x
    s_cbranch_vccnz L_retry_13l
L_retry_13x:
    s_nop 7
    s_branch L_ok_14
L_retry_15:
    s_nop 15
    s_nop 7
    s_mov_b32 s69, 16384
L_retry_15l:
    buffer_load_dwordx4 v[72:75], v1, s[48:51], s55 offen offset:2048 sc1
    buffer_load_dwordx4 v[76:79], v1, s[48:51], s55 offen offset:3072 sc1
    buffer_load_dwordx4 v[80:83], v1, s[48:51], s72 offen sc1
    buffer_load_dwordx4 v[84:87], v1, s[48:51], s72 offen offset:1024 sc1
    s_waitcnt vmcnt(0)
    v_max3_u32 v30, v72, v74, v76
    v_max3_u32 v30, v78, v80, v30
    v_max3_u32 v30, v82, v84, v30
    v_max_u32 v30, v86, v30
    v_cmp_eq_u32 vcc, -1, v30
    s_sub_u32 s69, s69, 1
    s_nop 3
    s_cbranch_scc1 L_retry_15x
    s_cbranch_vccnz L_retry_15l
L_retry_15x:
    s_nop 7
    s_branch L_ok_16
L_slow_17:
    s_nop 15
    s_nop 7
    buffer_store_dwordx4 v[96:99], v1, s[48:51], s52 offen sc1
    s_nop 1
    buffer_store_dwordx4 v[100:103], v1, s[48:51], s52 offen offset:1024 sc1
    s_nop 1
    s_nop 7
    s_branch L_back_18
L_slow_19:
    s_nop 15
    s_nop 7
    buffer_store_dword v28, v88, s[48:51], s62 offen sc1
    s_nop 1
    s_nop 7
    s_branch L_back_20
L_skip2:
    s_nop 15
    s_nop 7
    s_mul_i32 s56, s3, 28672
    s_add_u32 s56, s56, s63
    s_add_u32 s56, s56, 114688
    s_add_u32 s57, s56, 4096
    s_add_u32 s58, s56, 8192
    s_add_u32 s59, s56, 12288
    s_add_u32 s60, s56, 16384
    s_add_u32 s75, s56, 20480
    s_add_u32 s99, s56, 24576
    s_lshl_b32 s70, s3, 11
    s_add_u32 s70, s70, s63
    s_add_u32 s70, s70, 229376
    v_lshrrev_b32 v13, 4, v0
    v_lshlrev_b32 v13, 4, v13
    v_and_b32 v90, 15, v0
    v_lshl_add_u32 v12, v90, 6, v13
    v_add_u32 v13, 162816, v13
    v_subrev_u32 v24, 48, v0
    v_ashrrev_i32 v24, 31, v24
    v_lshrrev_b32 v89, 2, v0
    v_mul_u32_u24 v89, 224, v89
    v_and_b32 v90, 3, v0
    v_lshl_add_u32 v89, v90, 3, v89
    s_lshl_b32 s7, s73, 5
    s_add_u32 s7, s7, 58368
    v_add_u32 v7, s7, v89
    v_add_u32 v8, 50176, v7
    s_cmp_eq_u32 s73, 0
    s_cselect_b32 s7, 192, 0
    s_add_u32 s7, s7, 58368
    v_add_u32 v5, s7, v89
    v_add_u32 v6, 50176, v5
    s_add_u32 s61, s3, s73
    s_lshl_b32 s61, s61, 5
    s_add_u32 s61, s61, 58368
    v_add_u32 v14, s61, v89
    s_add_u32 s61, s61, 128
    s_cmp_ge_u32 s3, 2
    s_cselect_b32 s7, s7, s61
    v_add_u32 v15, s7, v89
    s_lshl_b32 s7, s3, 6
    v_add_u32 v26, s7, v13
    s_add_u32 s7, s3, 4
    s_min_u32 s7, s7, 6
    s_lshl_b32 s7, s7, 6
    v_add_u32 v27, s7, v13
    s_and_b32 s74, s5, 1
    s_lshl_b32 s74, s74, 2
    s_add_u32 s74, s74, s3
    s_lshl_b32 s74, s74, 13
    s_add_u32 s74, s74, s63
    s_add_u32 s74, s74, 262144
    buffer_load_dword a255, v20, s[48:51], s74 offen
    s_add_u32 s74, s74, 65536
    buffer_load_dword a255, v20, s[48:51], s74 offen
    s_add_u32 s74, s74, 65536
    s_waitcnt vmcnt(0)
    s_nop 7
    s_branch L_join2
L_hre_21:
    s_nop 15
    s_nop 7
    s_mov_b32 s69, 16384
L_hs_1:
    buffer_load_dwordx4 v[248:251], v12, s[48:51], s70 offen sc1
    buffer_load_dwordx4 v[252:255], v12, s[48:51], s70 offen offset:1024 sc1
    s_waitcnt vmcnt(0)
    v_and_b32 v250, v250, v24
    v_and_b32 v251, v251, v24
    v_and_b32 v254, v254, v24
    v_and_b32 v255, v255, v24
    s_waitcnt vmcnt(0)
    v_max3_u32 v30, v248, v249, v250
    v_max3_u32 v30, v251, v252, v30
    v_max3_u32 v30, v253, v254, v30
    v_max_u32 v30, v255, v30
    v_cmp_eq_u32 vcc, -1, v30
    s_sub_u32 s69, s69, 1
    s_cbranch_scc1 L_hsx_2
    s_cbranch_vccnz L_hs_1
L_hsx_2:
    s_mov_b32 s69, 16384
    s_nop 0
L_hh_3:
    buffer_load_dwordx4 v[128:131], v1, s[48:51], s56 offen sc1
    buffer_load_dwordx4 v[132:135], v1, s[48:51], s59 offen offset:2048 sc1
    buffer_load_dwordx4 v[136:139], v1, s[48:51], s56 offen offset:1024 sc1
    buffer_load_dwordx4 v[140:143], v1, s[48:51], s59 offen offset:3072 sc1
    buffer_load_dwordx4 v[144:147], v1, s[48:51], s56 offen offset:2048 sc1
    buffer_load_dwordx4 v[148:151], v1, s[48:51], s60 offen sc1
    buffer_load_dwordx4 v[152:155], v1, s[48:51], s56 offen offset:3072 sc1
    buffer_load_dwordx4 v[156:159], v1, s[48:51], s60 offen offset:1024 sc1
    buffer_load_dwordx4 v[160:163], v1, s[48:51], s57 offen sc1
    buffer_load_dwordx4 v[164:167], v1, s[48:51], s60 offen offset:2048 sc1
    s_waitcnt vmcnt(0)
    v_max3_u32 v30, v128, v130, v132
    v_max3_u32 v30, v134, v136, v30
    v_max3_u32 v30, v138, v140, v30
    v_max_u32 v30, v142, v30
    v_cmp_eq_u32 vcc, -1, v30
    s_sub_u32 s69, s69, 1
    s_cbranch_scc1 L_hhx_4
    s_cbranch_vccnz L_hh_3
L_hhx_4:
    s_nop 7
    s_branch L_hok_22
L_retry_23:
    s_nop 15
    s_nop 7
    s_mov_b32 s69, 16384
L_retry_23l:
    buffer_load_dwordx4 v[144:147], v1, s[48:51], s56 offen offset:2048 sc1
    buffer_load_dwordx4 v[148:151], v1, s[48:51], s60 offen sc1
    buffer_load_dwordx4 v[152:155], v1, s[48:51], s56 offen offset:3072 sc1
    buffer_load_dwordx4 v[156:159], v1, s[48:51], s60 offen offset:1024 sc1
    buffer_load_dwordx4 v[160:163], v1, s[48:51], s57 offen sc1
    buffer_load_dwordx4 v[164:167], v1, s[48:51], s60 offen offset:2048 sc1
    s_waitcnt vmcnt(0)
    v_max3_u32 v30, v144, v146, v148
    v_max3_u32 v30, v150, v152, v30
    v_max3_u32 v30, v154, v156, v30
    v_max3_u32 v30, v158, v160, v30
    v_max3_u32 v30, v162, v164, v30
    v_max_u32 v30, v166, v30
    v_cmp_eq_u32 vcc, -1, v30
    s_sub_u32 s69, s69, 1
    s_nop 3
    s_cbranch_scc1 L_retry_23x
    s_cbranch_vccnz L_retry_23l
L_retry_23x:
    s_nop 7
    s_branch L_ok_24
L_retry_25:
    s_nop 15
    s_nop 7
    s_mov_b32 s69, 16384
L_retry_25l:
    buffer_load_dwordx4 v[168:171], v1, s[48:51], s57 offen offset:1024 sc1
    buffer_load_dwordx4 v[172:175], v1, s[48:51], s60 offen offset:3072 sc1
    buffer_load_dwordx4 v[176:179], v1, s[48:51], s57 offen offset:2048 sc1
    buffer_load_dwordx4 v[180:183], v1, s[48:51], s75 offen sc1
    buffer_load_dwordx4 v[184:187], v1, s[48:51], s57 offen offset:3072 sc1
    buffer_load_dwordx4 v[188:191], v1, s[48:51], s75 offen offset:1024 sc1
    s_waitcnt vmcnt(0)
    v_max3_u32 v30, v168, v170, v172
    v_max3_u32 v30, v174, v176, v30
    v_max3_u32 v30, v178, v180, v30
    v_max3_u32 v30, v182, v184, v30
    v_max3_u32 v30, v186, v188, v30
    v_max_u32 v30, v190, v30
    v_cmp_eq_u32 vcc, -1, v30
    s_sub_u32 s69, s69, 1
    s_nop 3
    s_cbranch_scc1 L_retry_25x
    s_cbranch_vccnz L_retry_25l
L_retry_25x:
    s_nop 7
    s_branch L_ok_26
L_retry_27:
    s_nop 15
    s_nop 7
    s_mov_b32 s69, 16384
L_retry_27l:
    buffer_load_dwordx4 v[192:195], v1, s[48:51], s58 offen sc1
    buffer_load_dwordx4 v[196:199], v1, s[48:51], s75 offen offset:2048 sc1
    buffer_load_dwordx4 v[200:203], v1, s[48:51], s58 offen offset:1024 sc1
    buffer_load_dwordx4 v[204:207], v1, s[48:51], s75 offen offset:3072 sc1
    buffer_load_dwordx4 v[208:211], v1, s[48:51], s58 offen offset:2048 sc1
    buffer_load_dwordx4 v[212:215], v1, s[48:51], s99 offen sc1
    s_waitcnt vmcnt(0)
    v_max3_u32 v30, v192, v194, v196
    v_max3_u32 v30, v198, v200, v30
    v_max3_u32 v30, v202, v204, v30
    v_max3_u32 v30, v206, v208, v30
    v_max3_u32 v30, v210, v212, v30
    v_max_u32 v30, v214, v30
    v_cmp_eq_u32 vcc, -1, v30
    s_sub_u32 s69, s69, 1
    s_nop 3
    s_cbranch_scc1 L_retry_27x
    s_cbranch_vccnz L_retry_27l
L_retry_27x:
    s_nop 7
    s_branch L_ok_28
L_retry_29:
    s_nop 15
    s_nop 7
    s_mov_b32 s69, 16384
L_retry_29l:
    buffer_load_dwordx4 v[216:219], v1, s[48:51], s58 offen offset:3072 sc1
    buffer_load_dwordx4 v[220:223], v1, s[48:51], s99 offen offset:1024 sc1
    buffer_load_dwordx4 v[224:227], v1, s[48:51], s59 offen sc1
    buffer_load_dwordx4 v[228:231], v1, s[48:51], s99 offen offset:2048 sc1
    buffer_load_dwordx4 v[232:235], v1, s[48:51], s59 offen offset:1024 sc1
    buffer_load_dwordx4 v[236:239], v1, s[48:51], s99 offen offset:3072 sc1
    s_waitcnt vmcnt(0)
    v_max3_u32 v30, v216, v218, v220
    v_max3_u32 v30, v222, v224, v30
    v_max3_u32 v30, v226, v228, v30
    v_max3_u32 v30, v230, v232, v30
    v_max3_u32 v30, v234, v236, v30
    v_max_u32 v30, v238, v30
    v_cmp_eq_u32 vcc, -1, v30
    s_sub_u32 s69, s69, 1
    s_nop 3
    s_cbranch_scc1 L_retry_29x
    s_cbranch_vccnz L_retry_29l
L_retry_29x:
    s_nop 7
    s_branch L_ok_30
L_slow_31:
    s_nop 15
    s_nop 7
    s_add_u32 s61, s72, 0
    s_nop 1
    buffer_store_dwordx4 v[240:243], v1, s[48:51], s61 offen sc1
    s_nop 1
    s_nop 7
    s_branch L_back_32
L_slow_33:
    s_nop 15
    s_nop 7
    s_add_u32 s61, s72, 14336
    s_nop 1
    buffer_store_dwordx4 v[244:247], v1, s[48:51], s61 offen sc1
    s_nop 1
    s_nop 7
    s_branch L_back_34
L_slow_35:
    s_nop 15
    s_nop 7
    s_add_u32 s61, s72, 1024
    s_nop 1
    buffer_store_dwordx4 v[240:243], v1, s[48:51], s61 offen sc1
    s_nop 1
    s_nop 7
    s_branch L_back_36
L_slow_37:
    s_nop 15
    s_nop 7
    s_add_u32 s61, s72, 15360
    s_nop 1
    buffer_store_dwordx4 v[244:247], v1, s[48:51], s61 offen sc1
    s_nop 1
    s_nop 7
    s_branch L_back_38
L_slow_39:
    s_nop 15
    s_nop 7
    s_add_u32 s61, s72, 2048
    s_nop 1
    buffer_store_dwordx4 v[240:243], v1, s[48:51], s61 offen sc1
    s_nop 1
    s_nop 7
    s_branch L_back_40
L_slow_41:
    s_nop 15
    s_nop 7
    s_add_u32 s61, s72, 16384
    s_nop 1
    buffer_store_dwordx4 v[244:247], v1, s[48:51], s61 offen sc1
    s_nop 1
    s_nop 7
    s_branch L_back_42
L_slow_43:
    s_nop 15
    s_nop 7
    s_mov_b64 exec, 1
    s_nop 1
    buffer_store_dword v31, off, s[48:51], s70 offset:0 sc1
    s_nop 1
    s_mov_b64 exec, -1
    s_nop 1
    s_nop 7
    s_branch L_back_44
L_slow_45:
    s_nop 15
    s_nop 7
    s_add_u32 s61, s62, 0
    s_nop 1
    buffer_store_dwordx2 v[240:241], v1, s[48:51], s61 offen sc1
    s_nop 1
    s_nop 7
    s_branch L_back_46
L_slow_47:
    s_nop 15
    s_nop 7
    s_add_u32 s61, s62, 14336
    s_nop 1
    buffer_store_dwordx2 v[244:245], v1, s[48:51], s61 offen sc1
    s_nop 1
    s_nop 7
    s_branch L_back_48
L_skip4:
    s_waitcnt vmcnt(0)
    v_mov_b32 v31, 1
    s_mov_b64 exec, 1
    buffer_store_dword v31, off, s[48:51], s70 offset:256 sc1
    s_mov_b64 exec, -1
    s_nop 7
    s_lshl_b32 s7, s5, 2
    s_add_u32 s7, s7, s3
    s_and_b32 s61, s4, 1
    s_lshl_b32 s61, s61, 8
    s_add_u32 s7, s7, s61
    s_cmp_lg_u32 s7, 56
    s_cbranch_scc1 L_fin
    s_cmp_eq_u32 s65, 0
    s_cbranch_scc1 L_fin
    v_min_u32 v30, 55, v0
    v_lshlrev_b32 v30, 2, v30
    s_mul_i32 s61, s4, 720896
    s_add_u32 s61, s61, 2335232
    s_add_u32 s62, s61, 720896
    s_mov_b32 s69, 100
L_wbl:
    buffer_load_dword v31, v30, s[48:51], s61 offen sc1
    buffer_load_dword v15, v30, s[48:51], s62 offen sc1
    s_waitcnt vmcnt(0)
    v_or_b32 v31, v31, v15
    v_cmp_ne_u32 vcc, 1, v31
    s_sub_u32 s69, s69, 1
    s_cbranch_scc1 L_fin
    s_nop 4
    s_cbranch_vccnz L_wbl
    buffer_wbl2 sc1
    s_waitcnt vmcnt(0)
    s_branch L_fin
L_fl_49:
    s_nop 15
    s_nop 7
    s_mov_b32 s69, 16384
L_fl_49l:
    buffer_load_dword v15, v14, s[48:51], s52 offen sc1
    s_waitcnt vmcnt(0)
    v_cmp_ne_u32 vcc, 1, v15
    s_sub_u32 s69, s69, 1
    s_cbranch_scc1 L_fl_49x
    s_nop 4
    s_cbranch_vccnz L_fl_49l
L_fl_49x:
    s_nop 7
    s_branch L_flok_50
L_slow_51:
    s_nop 15
    s_nop 7
    s_mov_b64 exec, 1
    s_nop 1
    buffer_store_dword v31, off, s[48:51], s70 offset:256 sc1
    s_nop 1
    s_mov_b64 exec, -1
    s_nop 1
    s_nop 7
    s_branch L_back_52
L_retry_53:
    s_nop 15
    s_nop 7
    s_mov_b32 s69, 16384
L_retry_53l:
    buffer_load_dwordx4 v[96:99], v17, s[48:51], s58 offen sc1
    buffer_load_dwordx4 v[100:103], v17, s[48:51], s58 offen offset:512 sc1
    s_waitcnt vmcnt(0)
    v_max3_u32 v30, v96, v98, v100
    v_max_u32 v30, v102, v30
    v_cmp_eq_u32 vcc, -1, v30
    s_sub_u32 s69, s69, 1
    s_nop 3
    s_cbranch_scc1 L_retry_53x
    s_cbranch_vccnz L_retry_53l
L_retry_53x:
    s_nop 7
    s_branch L_ok_54
L_fl_55:
    s_nop 15
    s_nop 7
    s_mov_b32 s69, 16384
L_fl_55l:
    buffer_load_dword v15, v14, s[48:51], s52 offen offset:256 sc1
    s_waitcnt vmcnt(0)
    v_cmp_ne_u32 vcc, 1, v15
    s_sub_u32 s69, s69, 1
    s_cbranch_scc1 L_fl_55x
    s_nop 4
    s_cbranch_vccnz L_fl_55l
L_fl_55x:
    s_nop 7
    s_branch L_flok_56
.section .rodata,"a"
.p2align 6
.amdhsa_kernel sequential_preLN__linear_kernel_hedgehog__dense_activation_squared_relu__prompt_kernel
  .amdhsa_next_free_vgpr 512
  .amdhsa_next_free_sgpr 102
  .amdhsa_accum_offset 256
  .amdhsa_group_segment_fixed_size 0
  .amdhsa_kernarg_size 96
  .amdhsa_user_sgpr_count 2
  .amdhsa_user_sgpr_kernarg_segment_ptr 1
  .amdhsa_system_sgpr_workgroup_id_x 1
.end_amdhsa_kernel
```
